```python
import torch

def _softmax(x, axis=-1):
    return torch.softmax(x, dim=axis)
def _gelu(x):
    return torch.nn.functional.gelu(x, approximate="tanh")
def _silu(x):
    return torch.nn.functional.silu(x)
def _sigmoid(x):
    return torch.sigmoid(x)
def _layernorm(x, axis=-1, eps=1e-5):
    m = x.mean(dim=axis, keepdim=True)
    v = x.var(dim=axis, keepdim=True, unbiased=False)
    return (x - m) / torch.sqrt(v + eps)
def _scatter_add(tgt, idx, src, axis=0):
    return tgt.clone().index_add_(axis, idx, src)
def _segment_sum(src, seg, n):
    out = torch.zeros((n,) + src.shape[1:], dtype=src.dtype)
    return out.index_add_(0, seg, src)
def _pad(x, pw):
    flat = tuple(v for pair in reversed(pw) for v in pair)
    return torch.nn.functional.pad(x, flat)

kernel_name = 'gather_scatter__molecular_angular_gemnet__graph'

def setup_inputs():

    _w = (lambda a: (lambda t: t.to(torch.bfloat16) if t.is_floating_point() else t)(torch.as_tensor(a)))
    N, deg, De, L = 25000, 32, 4, 1
    E = N * deg
    T = E * deg
    NR = 8
    dist = torch.rand(E).to(float)
    angle = (torch.rand(T) * torch.pi).to(float)
    centers = torch.linspace(0.0, 1.0, NR).to(float)
    ang_freq = torch.arange(1, L + 1).to(float)
    return {
        "m": _w((lambda *s: torch.randn(*s, dtype=torch.bfloat16) * 0.05)(E, De)),
        "idx_in": _w((lambda lo, hi, *s: torch.randint(lo, hi, s))(0, E, T).to(torch.int64)),
        "idx_out": _w((lambda lo, hi, *s: torch.randint(lo, hi, s))(0, E, T).to(torch.int64)),
        "dist": _w(dist),
        "angle": _w(angle),
        "centers": _w(centers),
        "ang_freq": _w(ang_freq),
        "w_rbf": _w((lambda *s: torch.randn(*s, dtype=torch.bfloat16) * 0.2)(NR, De)),
        "w_sbf": _w((lambda *s: torch.randn(*s, dtype=torch.bfloat16) * 0.2)(NR * L, De)),
        "w_down": _w((lambda *s: torch.randn(*s, dtype=torch.bfloat16) * 0.2)(De, De)),
        "w_up": _w((lambda *s: torch.randn(*s, dtype=torch.bfloat16) * 0.2)(De, De)),
    }

def reference(m, idx_in, idx_out, dist, angle, centers, ang_freq, w_rbf, w_sbf, w_down, w_up):
    E, De = m.shape[0], m.shape[1]
    NR = centers.shape[0]
    L = ang_freq.shape[0]
    rbf = torch.exp(-10.0 * (dist[:, None] - centers[None, :]) ** 2)
    cbf = torch.cos(ang_freq[None, :] * angle[:, None])
    rbf_t = rbf[idx_out]
    sbf = torch.reshape(rbf_t[:, :, None] * cbf[:, None, :], (-1, NR * L))
    x = (m[idx_in] @ w_down) * (sbf @ w_sbf)
    agg = _segment_sum(x, idx_out, E)
    return m + (agg @ w_up) * (rbf @ w_rbf)
```

```asm
; @launch kernel=part_kernel grid=(256,1,1) block=(1024,1,1) lds=141952
; @launch kernel=acc_kernel grid=(256,1,1) block=(1024,1,1) lds=159200
; @launch kernel=fin_kernel grid=(3125,1,1) block=(256,1,1) lds=0
.amdgcn_target "amdgcn-amd-amdhsa--gfx950"
.text
.globl part_kernel
.p2align 8
.type part_kernel,@function
part_kernel:
    s_cmp_ge_u32 s2, 256
    s_cbranch_scc1 A_end
    s_load_dwordx4 s[40:43], s[0:1], 0
    s_load_dwordx2 s[44:45], s[0:1], 16
    s_load_dwordx2 s[46:47], s[0:1], 32
    s_load_dwordx2 s[48:49], s[0:1], 48
    s_load_dwordx2 s[50:51], s[0:1], 104
    v_lshlrev_b32 v1, 4, v0
    v_lshrrev_b32 v104, 6, v0
    s_nop 0
    v_readfirstlane_b32 s28, v104
    s_waitcnt lgkmcnt(0)
    s_load_dword s52, s[48:49], 0
    s_mov_b32 s16, s40
    s_and_b32 s17, s41, 0xffff
    s_mov_b32 s18, 6400000
    s_mov_b32 s19, 0x00020000
    s_mov_b32 s4, s42
    s_and_b32 s5, s43, 0xffff
    s_mov_b32 s6, 102400000
    s_mov_b32 s7, 0x00020000
    s_mov_b32 s8, s44
    s_and_b32 s9, s45, 0xffff
    s_mov_b32 s10, 102400000
    s_mov_b32 s11, 0x00020000
    s_mov_b32 s12, s46
    s_and_b32 s13, s47, 0xffff
    s_mov_b32 s14, 51200000
    s_mov_b32 s15, 0x00020000
    s_mov_b32 s20, s50
    s_and_b32 s21, s51, 0xffff
    s_mov_b32 s22, 409600000
    s_mov_b32 s23, 0x00020000
    s_mov_b32 s24, 0xffff0000
    s_mov_b32 s32, -100000
    s_mov_b32 s25, s2
    s_mov_b32 s29, s2
    s_mul_i32 s31, s29, 81920
    v_add_u32 v126, s31, v1
    buffer_load_dwordx4 v[4:7], v126, s[4:7], 0 offen nt
    buffer_load_dwordx4 v[24:27], v126, s[8:11], 0 offen nt
    v_lshrrev_b32 v105, 1, v126
    buffer_load_dwordx2 v[44:45], v105, s[12:15], 0 offen nt
    v_add_u32 v106, 16384, v126
    buffer_load_dwordx4 v[8:11], v106, s[4:7], 0 offen nt
    buffer_load_dwordx4 v[28:31], v106, s[8:11], 0 offen nt
    v_lshrrev_b32 v107, 1, v106
    buffer_load_dwordx2 v[46:47], v107, s[12:15], 0 offen nt
    v_add_u32 v104, 32768, v126
    buffer_load_dwordx4 v[12:15], v104, s[4:7], 0 offen nt
    buffer_load_dwordx4 v[32:35], v104, s[8:11], 0 offen nt
    v_lshrrev_b32 v105, 1, v104
    buffer_load_dwordx2 v[48:49], v105, s[12:15], 0 offen nt
    v_add_u32 v106, 49152, v126
    buffer_load_dwordx4 v[16:19], v106, s[4:7], 0 offen nt
    buffer_load_dwordx4 v[36:39], v106, s[8:11], 0 offen nt
    v_lshrrev_b32 v107, 1, v106
    buffer_load_dwordx2 v[50:51], v107, s[12:15], 0 offen nt
    v_add_u32 v104, 65536, v126
    buffer_load_dwordx4 v[20:23], v104, s[4:7], 0 offen nt
    buffer_load_dwordx4 v[40:43], v104, s[8:11], 0 offen nt
    v_lshrrev_b32 v105, 1, v104
    buffer_load_dwordx2 v[52:53], v105, s[12:15], 0 offen nt
    s_mul_i32 s30, s2, 3125
    s_lshr_b32 s30, s30, 1
    s_lshl_b32 s30, s30, 4
    v_add_u32 v108, s30, v1
    v_add_u32 v109, 16384, v108
    buffer_load_dwordx4 v[54:57], v108, s[16:19], 0 offen
    buffer_load_dwordx4 v[58:61], v109, s[16:19], 0 offen
    v_mov_b32 v110, 0
    v_lshlrev_b32 v111, 2, v0
    ds_write_b32 v111, v110 offset:0
    v_cmp_gt_u32 vcc, 128, v0
    s_and_saveexec_b64 s[38:39], vcc
    ds_write_b32 v111, v110 offset:8192
    s_mov_b64 exec, s[38:39]
    s_waitcnt lgkmcnt(0)
    s_and_b32 s52, s52, 0xffff
    s_lshl_b32 s52, s52, 16
    v_mov_b32 v2, s52
    v_mul_f32 v2, 0.15915494, v2
    v_mov_b32 v3, 0x3727c5ac
    v_mov_b32 v127, 1
    s_barrier
    s_waitcnt vmcnt(0)
    s_mov_b32 s30, 0x7fff7fff
    v_and_b32 v54, s30, v54
    v_and_b32 v55, s30, v55
    v_and_b32 v56, s30, v56
    v_and_b32 v57, s30, v57
    v_and_b32 v58, s30, v58
    v_and_b32 v59, s30, v59
    v_and_b32 v60, s30, v60
    v_and_b32 v61, s30, v61
    v_mov_b32 v62, 0
    v_lshlrev_b32 v63, 16, v54
    v_and_b32 v64, s24, v54
    v_add_f32 v62, v62, v63
    v_add_f32 v62, v62, v64
    v_lshlrev_b32 v63, 16, v55
    v_and_b32 v64, s24, v55
    v_add_f32 v62, v62, v63
    v_add_f32 v62, v62, v64
    v_lshlrev_b32 v63, 16, v56
    v_and_b32 v64, s24, v56
    v_add_f32 v62, v62, v63
    v_add_f32 v62, v62, v64
    v_lshlrev_b32 v63, 16, v57
    v_and_b32 v64, s24, v57
    v_add_f32 v62, v62, v63
    v_add_f32 v62, v62, v64
    v_lshlrev_b32 v63, 16, v58
    v_and_b32 v64, s24, v58
    v_add_f32 v62, v62, v63
    v_add_f32 v62, v62, v64
    v_lshlrev_b32 v63, 16, v59
    v_and_b32 v64, s24, v59
    v_add_f32 v62, v62, v63
    v_add_f32 v62, v62, v64
    v_lshlrev_b32 v63, 16, v60
    v_and_b32 v64, s24, v60
    v_add_f32 v62, v62, v63
    v_add_f32 v62, v62, v64
    v_lshlrev_b32 v63, 16, v61
    v_and_b32 v64, s24, v61
    v_add_f32 v62, v62, v63
    v_add_f32 v62, v62, v64
    s_nop 1
    v_add_f32_dpp v62, v62, v62 row_shr:1 row_mask:0xf bank_mask:0xf
    s_nop 1
    v_add_f32_dpp v62, v62, v62 row_shr:2 row_mask:0xf bank_mask:0xf
    s_nop 1
    v_add_f32_dpp v62, v62, v62 row_shr:4 row_mask:0xf bank_mask:0xf
    s_nop 1
    v_add_f32_dpp v62, v62, v62 row_shr:8 row_mask:0xf bank_mask:0xf
    s_nop 1
    v_add_f32_dpp v62, v62, v62 row_bcast:15 row_mask:0xa bank_mask:0xf
    s_nop 1
    v_add_f32_dpp v62, v62, v62 row_bcast:31 row_mask:0xc bank_mask:0xf
    v_mov_b32 v63, 8452
    s_mov_b32 exec_lo, 0
    s_mov_b32 exec_hi, 0x80000000
    ds_add_f32 v63, v62
    s_mov_b64 exec, -1
    v_pk_max_u16 v54, v54, v58
    v_pk_max_u16 v55, v55, v59
    v_pk_max_u16 v56, v56, v60
    v_pk_max_u16 v57, v57, v61
    v_pk_max_u16 v54, v54, v56
    v_pk_max_u16 v55, v55, v57
    v_pk_max_u16 v54, v54, v55
    v_lshrrev_b32 v55, 16, v54
    v_and_b32 v54, 0xffff, v54
    v_max_u32 v54, v54, v55
    v_mov_b32 v55, 8448
    ds_max_u32 v55, v54
    s_waitcnt lgkmcnt(0)
    s_barrier
    s_cmp_lg_u32 s28, 0
    s_cbranch_scc1 A_nomax
    ds_read_b32 v54, v55
    ds_read_b32 v57, v55 offset:4
    s_lshl_b32 s30, s2, 2
    s_add_u32 s30, s30, 166400000
    v_mov_b32 v56, s30
    s_waitcnt lgkmcnt(0)
    v_cmp_eq_u32 vcc, 0, v0
    s_and_saveexec_b64 s[38:39], vcc
    buffer_store_dword v54, v56, s[20:23], 0 offen
    buffer_store_dword v57, v56, s[20:23], 0 offen offset:1024
    s_mov_b64 exec, s[38:39]
A_nomax:
    s_mov_b32 s26, 0
    s_mov_b32 s27, 0
A_tile:
    v_add_u32 v120, 0, v1
    v_add_u32 v122, 8704, v120
    v_cmp_gt_u32 s[34:35], s26, v120
    s_mov_b64 exec, s[34:35]
    ds_read_b128 v[112:115], v122
    s_mov_b64 exec, -1
    v_cvt_f32_u32 v104, v4
    v_lshrrev_b32 v105, 3, v24
    v_fmaak_f32 v104, v104, v3, 0x36a7c5ac
    v_and_b32 v105, 0x3f8, v105
    v_cvt_u32_f32 v104, v104
    v_mul_u32_u24 v107, 0x204, v104
    v_lshrrev_b32 v106, 7, v24
    v_and_b32 v107, 0xc04, v107
    v_or_b32 v105, v107, v105
    v_bfi_b32 v106, 63, v24, v106
    v_mad_i32_i24 v104, v104, s32, v4
    ds_add_rtn_u32 v74, v105, v127 offset:0
    v_lshl_or_b32 v54, v106, 17, v104
    v_lshlrev_b32 v24, 16, v105
    s_waitcnt lgkmcnt(1)
    s_mov_b64 exec, s[34:35]
    buffer_store_dwordx4 v[112:115], v120, s[20:23], s27 offen sc1
    s_mov_b64 exec, -1
    v_cvt_f32_u32 v108, v5
    v_lshrrev_b32 v109, 3, v25
    v_fmaak_f32 v108, v108, v3, 0x36a7c5ac
    v_and_b32 v109, 0x3f8, v109
    v_cvt_u32_f32 v108, v108
    v_mul_u32_u24 v111, 0x204, v108
    v_lshrrev_b32 v110, 7, v25
    v_and_b32 v111, 0xc04, v111
    v_or_b32 v109, v111, v109
    v_bfi_b32 v110, 63, v25, v110
    v_mad_i32_i24 v108, v108, s32, v5
    ds_add_rtn_u32 v75, v109, v127 offset:0
    v_lshl_or_b32 v55, v110, 17, v108
    v_lshlrev_b32 v25, 16, v109
    v_add_u32 v121, 16384, v1
    v_add_u32 v122, 8704, v121
    v_cmp_gt_u32 s[36:37], s26, v121
    s_mov_b64 exec, s[36:37]
    ds_read_b128 v[116:119], v122
    s_mov_b64 exec, -1
    v_cvt_f32_u32 v104, v6
    v_lshrrev_b32 v105, 3, v26
    v_fmaak_f32 v104, v104, v3, 0x36a7c5ac
    v_and_b32 v105, 0x3f8, v105
    v_cvt_u32_f32 v104, v104
    v_mul_u32_u24 v107, 0x204, v104
    v_lshrrev_b32 v106, 7, v26
    v_and_b32 v107, 0xc04, v107
    v_or_b32 v105, v107, v105
    v_bfi_b32 v106, 63, v26, v106
    v_mad_i32_i24 v104, v104, s32, v6
    ds_add_rtn_u32 v76, v105, v127 offset:0
    v_lshl_or_b32 v56, v106, 17, v104
    v_lshlrev_b32 v26, 16, v105
    s_waitcnt lgkmcnt(1)
    s_mov_b64 exec, s[36:37]
    buffer_store_dwordx4 v[116:119], v121, s[20:23], s27 offen sc1
    s_mov_b64 exec, -1
    v_cvt_f32_u32 v108, v7
    v_lshrrev_b32 v109, 3, v27
    v_fmaak_f32 v108, v108, v3, 0x36a7c5ac
    v_and_b32 v109, 0x3f8, v109
    v_cvt_u32_f32 v108, v108
    v_mul_u32_u24 v111, 0x204, v108
    v_lshrrev_b32 v110, 7, v27
    v_and_b32 v111, 0xc04, v111
    v_or_b32 v109, v111, v109
    v_bfi_b32 v110, 63, v27, v110
    v_mad_i32_i24 v108, v108, s32, v7
    ds_add_rtn_u32 v77, v109, v127 offset:0
    v_lshl_or_b32 v57, v110, 17, v108
    v_lshlrev_b32 v27, 16, v109
    v_cvt_f32_u32 v104, v8
    v_lshrrev_b32 v105, 3, v28
    v_fmaak_f32 v104, v104, v3, 0x36a7c5ac
    v_and_b32 v105, 0x3f8, v105
    v_cvt_u32_f32 v104, v104
    v_mul_u32_u24 v107, 0x204, v104
    v_lshrrev_b32 v106, 7, v28
    v_and_b32 v107, 0xc04, v107
    v_or_b32 v105, v107, v105
    v_bfi_b32 v106, 63, v28, v106
    v_mad_i32_i24 v104, v104, s32, v8
    ds_add_rtn_u32 v78, v105, v127 offset:0
    v_lshl_or_b32 v58, v106, 17, v104
    v_lshlrev_b32 v28, 16, v105
    v_add_u32 v120, 32768, v1
    v_add_u32 v122, 8704, v120
    v_cmp_gt_u32 s[34:35], s26, v120
    s_mov_b64 exec, s[34:35]
    ds_read_b128 v[112:115], v122
    s_mov_b64 exec, -1
    v_cvt_f32_u32 v108, v9
    v_lshrrev_b32 v109, 3, v29
    v_fmaak_f32 v108, v108, v3, 0x36a7c5ac
    v_and_b32 v109, 0x3f8, v109
    v_cvt_u32_f32 v108, v108
    v_mul_u32_u24 v111, 0x204, v108
    v_lshrrev_b32 v110, 7, v29
    v_and_b32 v111, 0xc04, v111
    v_or_b32 v109, v111, v109
    v_bfi_b32 v110, 63, v29, v110
    v_mad_i32_i24 v108, v108, s32, v9
    ds_add_rtn_u32 v79, v109, v127 offset:0
    v_lshl_or_b32 v59, v110, 17, v108
    v_lshlrev_b32 v29, 16, v109
    s_waitcnt lgkmcnt(1)
    s_mov_b64 exec, s[34:35]
    buffer_store_dwordx4 v[112:115], v120, s[20:23], s27 offen sc1
    s_mov_b64 exec, -1
    v_cvt_f32_u32 v104, v10
    v_lshrrev_b32 v105, 3, v30
    v_fmaak_f32 v104, v104, v3, 0x36a7c5ac
    v_and_b32 v105, 0x3f8, v105
    v_cvt_u32_f32 v104, v104
    v_mul_u32_u24 v107, 0x204, v104
    v_lshrrev_b32 v106, 7, v30
    v_and_b32 v107, 0xc04, v107
    v_or_b32 v105, v107, v105
    v_bfi_b32 v106, 63, v30, v106
    v_mad_i32_i24 v104, v104, s32, v10
    ds_add_rtn_u32 v80, v105, v127 offset:0
    v_lshl_or_b32 v60, v106, 17, v104
    v_lshlrev_b32 v30, 16, v105
    v_add_u32 v121, 49152, v1
    v_add_u32 v122, 8704, v121
    v_cmp_gt_u32 s[36:37], s26, v121
    s_mov_b64 exec, s[36:37]
    ds_read_b128 v[116:119], v122
    s_mov_b64 exec, -1
    v_cvt_f32_u32 v108, v11
    v_lshrrev_b32 v109, 3, v31
    v_fmaak_f32 v108, v108, v3, 0x36a7c5ac
    v_and_b32 v109, 0x3f8, v109
    v_cvt_u32_f32 v108, v108
    v_mul_u32_u24 v111, 0x204, v108
    v_lshrrev_b32 v110, 7, v31
    v_and_b32 v111, 0xc04, v111
    v_or_b32 v109, v111, v109
    v_bfi_b32 v110, 63, v31, v110
    v_mad_i32_i24 v108, v108, s32, v11
    ds_add_rtn_u32 v81, v109, v127 offset:0
    v_lshl_or_b32 v61, v110, 17, v108
    v_lshlrev_b32 v31, 16, v109
    s_waitcnt lgkmcnt(1)
    s_mov_b64 exec, s[36:37]
    buffer_store_dwordx4 v[116:119], v121, s[20:23], s27 offen sc1
    s_mov_b64 exec, -1
    v_cvt_f32_u32 v104, v12
    v_lshrrev_b32 v105, 3, v32
    v_fmaak_f32 v104, v104, v3, 0x36a7c5ac
    v_and_b32 v105, 0x3f8, v105
    v_cvt_u32_f32 v104, v104
    v_mul_u32_u24 v107, 0x204, v104
    v_lshrrev_b32 v106, 7, v32
    v_and_b32 v107, 0xc04, v107
    v_or_b32 v105, v107, v105
    v_bfi_b32 v106, 63, v32, v106
    v_mad_i32_i24 v104, v104, s32, v12
    ds_add_rtn_u32 v82, v105, v127 offset:0
    v_lshl_or_b32 v62, v106, 17, v104
    v_lshlrev_b32 v32, 16, v105
    v_cvt_f32_u32 v108, v13
    v_lshrrev_b32 v109, 3, v33
    v_fmaak_f32 v108, v108, v3, 0x36a7c5ac
    v_and_b32 v109, 0x3f8, v109
    v_cvt_u32_f32 v108, v108
    v_mul_u32_u24 v111, 0x204, v108
    v_lshrrev_b32 v110, 7, v33
    v_and_b32 v111, 0xc04, v111
    v_or_b32 v109, v111, v109
    v_bfi_b32 v110, 63, v33, v110
    v_mad_i32_i24 v108, v108, s32, v13
    ds_add_rtn_u32 v83, v109, v127 offset:0
    v_lshl_or_b32 v63, v110, 17, v108
    v_lshlrev_b32 v33, 16, v109
    v_add_u32 v120, 65536, v1
    v_add_u32 v122, 8704, v120
    v_cmp_gt_u32 s[34:35], s26, v120
    s_mov_b64 exec, s[34:35]
    ds_read_b128 v[112:115], v122
    s_mov_b64 exec, -1
    v_cvt_f32_u32 v104, v14
    v_lshrrev_b32 v105, 3, v34
    v_fmaak_f32 v104, v104, v3, 0x36a7c5ac
    v_and_b32 v105, 0x3f8, v105
    v_cvt_u32_f32 v104, v104
    v_mul_u32_u24 v107, 0x204, v104
    v_lshrrev_b32 v106, 7, v34
    v_and_b32 v107, 0xc04, v107
    v_or_b32 v105, v107, v105
    v_bfi_b32 v106, 63, v34, v106
    v_mad_i32_i24 v104, v104, s32, v14
    ds_add_rtn_u32 v84, v105, v127 offset:0
    v_lshl_or_b32 v64, v106, 17, v104
    v_lshlrev_b32 v34, 16, v105
    s_waitcnt lgkmcnt(1)
    s_mov_b64 exec, s[34:35]
    buffer_store_dwordx4 v[112:115], v120, s[20:23], s27 offen sc1
    s_mov_b64 exec, -1
    v_cvt_f32_u32 v108, v15
    v_lshrrev_b32 v109, 3, v35
    v_fmaak_f32 v108, v108, v3, 0x36a7c5ac
    v_and_b32 v109, 0x3f8, v109
    v_cvt_u32_f32 v108, v108
    v_mul_u32_u24 v111, 0x204, v108
    v_lshrrev_b32 v110, 7, v35
    v_and_b32 v111, 0xc04, v111
    v_or_b32 v109, v111, v109
    v_bfi_b32 v110, 63, v35, v110
    v_mad_i32_i24 v108, v108, s32, v15
    ds_add_rtn_u32 v85, v109, v127 offset:0
    v_lshl_or_b32 v65, v110, 17, v108
    v_lshlrev_b32 v35, 16, v109
    v_add_u32 v121, 81920, v1
    v_add_u32 v122, 8704, v121
    v_cmp_gt_u32 s[36:37], s26, v121
    s_mov_b64 exec, s[36:37]
    ds_read_b128 v[116:119], v122
    s_mov_b64 exec, -1
    v_cvt_f32_u32 v104, v16
    v_lshrrev_b32 v105, 3, v36
    v_fmaak_f32 v104, v104, v3, 0x36a7c5ac
    v_and_b32 v105, 0x3f8, v105
    v_cvt_u32_f32 v104, v104
    v_mul_u32_u24 v107, 0x204, v104
    v_lshrrev_b32 v106, 7, v36
    v_and_b32 v107, 0xc04, v107
    v_or_b32 v105, v107, v105
    v_bfi_b32 v106, 63, v36, v106
    v_mad_i32_i24 v104, v104, s32, v16
    ds_add_rtn_u32 v86, v105, v127 offset:0
    v_lshl_or_b32 v66, v106, 17, v104
    v_lshlrev_b32 v36, 16, v105
    s_waitcnt lgkmcnt(1)
    s_mov_b64 exec, s[36:37]
    buffer_store_dwordx4 v[116:119], v121, s[20:23], s27 offen sc1
    s_mov_b64 exec, -1
    v_cvt_f32_u32 v108, v17
    v_lshrrev_b32 v109, 3, v37
    v_fmaak_f32 v108, v108, v3, 0x36a7c5ac
    v_and_b32 v109, 0x3f8, v109
    v_cvt_u32_f32 v108, v108
    v_mul_u32_u24 v111, 0x204, v108
    v_lshrrev_b32 v110, 7, v37
    v_and_b32 v111, 0xc04, v111
    v_or_b32 v109, v111, v109
    v_bfi_b32 v110, 63, v37, v110
    v_mad_i32_i24 v108, v108, s32, v17
    ds_add_rtn_u32 v87, v109, v127 offset:0
    v_lshl_or_b32 v67, v110, 17, v108
    v_lshlrev_b32 v37, 16, v109
    v_cvt_f32_u32 v104, v18
    v_lshrrev_b32 v105, 3, v38
    v_fmaak_f32 v104, v104, v3, 0x36a7c5ac
    v_and_b32 v105, 0x3f8, v105
    v_cvt_u32_f32 v104, v104
    v_mul_u32_u24 v107, 0x204, v104
    v_lshrrev_b32 v106, 7, v38
    v_and_b32 v107, 0xc04, v107
    v_or_b32 v105, v107, v105
    v_bfi_b32 v106, 63, v38, v106
    v_mad_i32_i24 v104, v104, s32, v18
    ds_add_rtn_u32 v88, v105, v127 offset:0
    v_lshl_or_b32 v68, v106, 17, v104
    v_lshlrev_b32 v38, 16, v105
    v_add_u32 v120, 98304, v1
    v_add_u32 v122, 8704, v120
    v_cmp_gt_u32 s[34:35], s26, v120
    s_mov_b64 exec, s[34:35]
    ds_read_b128 v[112:115], v122
    s_mov_b64 exec, -1
    v_cvt_f32_u32 v108, v19
    v_lshrrev_b32 v109, 3, v39
    v_fmaak_f32 v108, v108, v3, 0x36a7c5ac
    v_and_b32 v109, 0x3f8, v109
    v_cvt_u32_f32 v108, v108
    v_mul_u32_u24 v111, 0x204, v108
    v_lshrrev_b32 v110, 7, v39
    v_and_b32 v111, 0xc04, v111
    v_or_b32 v109, v111, v109
    v_bfi_b32 v110, 63, v39, v110
    v_mad_i32_i24 v108, v108, s32, v19
    ds_add_rtn_u32 v89, v109, v127 offset:0
    v_lshl_or_b32 v69, v110, 17, v108
    v_lshlrev_b32 v39, 16, v109
    s_waitcnt lgkmcnt(1)
    s_mov_b64 exec, s[34:35]
    buffer_store_dwordx4 v[112:115], v120, s[20:23], s27 offen sc1
    s_mov_b64 exec, -1
    v_cvt_f32_u32 v104, v20
    v_lshrrev_b32 v105, 3, v40
    v_fmaak_f32 v104, v104, v3, 0x36a7c5ac
    v_and_b32 v105, 0x3f8, v105
    v_cvt_u32_f32 v104, v104
    v_mul_u32_u24 v107, 0x204, v104
    v_lshrrev_b32 v106, 7, v40
    v_and_b32 v107, 0xc04, v107
    v_or_b32 v105, v107, v105
    v_bfi_b32 v106, 63, v40, v106
    v_mad_i32_i24 v104, v104, s32, v20
    ds_add_rtn_u32 v90, v105, v127 offset:0
    v_lshl_or_b32 v70, v106, 17, v104
    v_lshlrev_b32 v40, 16, v105
    v_add_u32 v121, 114688, v1
    v_add_u32 v122, 8704, v121
    v_cmp_gt_u32 s[36:37], s26, v121
    s_mov_b64 exec, s[36:37]
    ds_read_b128 v[116:119], v122
    s_mov_b64 exec, -1
    v_cvt_f32_u32 v108, v21
    v_lshrrev_b32 v109, 3, v41
    v_fmaak_f32 v108, v108, v3, 0x36a7c5ac
    v_and_b32 v109, 0x3f8, v109
    v_cvt_u32_f32 v108, v108
    v_mul_u32_u24 v111, 0x204, v108
    v_lshrrev_b32 v110, 7, v41
    v_and_b32 v111, 0xc04, v111
    v_or_b32 v109, v111, v109
    v_bfi_b32 v110, 63, v41, v110
    v_mad_i32_i24 v108, v108, s32, v21
    ds_add_rtn_u32 v91, v109, v127 offset:0
    v_lshl_or_b32 v71, v110, 17, v108
    v_lshlrev_b32 v41, 16, v109
    s_waitcnt lgkmcnt(1)
    s_mov_b64 exec, s[36:37]
    buffer_store_dwordx4 v[116:119], v121, s[20:23], s27 offen sc1
    s_mov_b64 exec, -1
    v_cvt_f32_u32 v104, v22
    v_lshrrev_b32 v105, 3, v42
    v_fmaak_f32 v104, v104, v3, 0x36a7c5ac
    v_and_b32 v105, 0x3f8, v105
    v_cvt_u32_f32 v104, v104
    v_mul_u32_u24 v107, 0x204, v104
    v_lshrrev_b32 v106, 7, v42
    v_and_b32 v107, 0xc04, v107
    v_or_b32 v105, v107, v105
    v_bfi_b32 v106, 63, v42, v106
    v_mad_i32_i24 v104, v104, s32, v22
    ds_add_rtn_u32 v92, v105, v127 offset:0
    v_lshl_or_b32 v72, v106, 17, v104
    v_lshlrev_b32 v42, 16, v105
    v_cvt_f32_u32 v108, v23
    v_lshrrev_b32 v109, 3, v43
    v_fmaak_f32 v108, v108, v3, 0x36a7c5ac
    v_and_b32 v109, 0x3f8, v109
    v_cvt_u32_f32 v108, v108
    v_mul_u32_u24 v111, 0x204, v108
    v_lshrrev_b32 v110, 7, v43
    v_and_b32 v111, 0xc04, v111
    v_or_b32 v109, v111, v109
    v_bfi_b32 v110, 63, v43, v110
    v_mad_i32_i24 v108, v108, s32, v23
    ds_add_rtn_u32 v93, v109, v127 offset:0
    v_lshl_or_b32 v73, v110, 17, v108
    v_lshlrev_b32 v43, 16, v109
    v_lshlrev_b32 v104, 16, v44
    v_and_b32 v105, s24, v44
    v_mul_f32 v104, v2, v104
    v_mul_f32 v105, v2, v105
    v_fract_f32 v104, v104
    v_fract_f32 v105, v105
    v_cos_f32 v104, v104
    v_cos_f32 v105, v105
    v_lshlrev_b32 v106, 16, v45
    v_and_b32 v107, s24, v45
    v_mul_f32 v106, v2, v106
    v_mul_f32 v107, v2, v107
    v_fract_f32 v106, v106
    v_fract_f32 v107, v107
    v_cos_f32 v106, v106
    v_cos_f32 v107, v107
    v_cvt_pk_bf16_f32 v94, v104, v105
    v_lshlrev_b32 v104, 16, v46
    v_and_b32 v105, s24, v46
    v_mul_f32 v104, v2, v104
    v_mul_f32 v105, v2, v105
    v_fract_f32 v104, v104
    v_fract_f32 v105, v105
    v_cos_f32 v104, v104
    v_cos_f32 v105, v105
    v_cvt_pk_bf16_f32 v95, v106, v107
    v_lshlrev_b32 v106, 16, v47
    v_and_b32 v107, s24, v47
    v_mul_f32 v106, v2, v106
    v_mul_f32 v107, v2, v107
    v_fract_f32 v106, v106
    v_fract_f32 v107, v107
    v_cos_f32 v106, v106
    v_cos_f32 v107, v107
    v_cvt_pk_bf16_f32 v96, v104, v105
    v_lshlrev_b32 v104, 16, v48
    v_and_b32 v105, s24, v48
    v_mul_f32 v104, v2, v104
    v_mul_f32 v105, v2, v105
    v_fract_f32 v104, v104
    v_fract_f32 v105, v105
    v_cos_f32 v104, v104
    v_cos_f32 v105, v105
    v_cvt_pk_bf16_f32 v97, v106, v107
    v_lshlrev_b32 v106, 16, v49
    v_and_b32 v107, s24, v49
    v_mul_f32 v106, v2, v106
    v_mul_f32 v107, v2, v107
    v_fract_f32 v106, v106
    v_fract_f32 v107, v107
    v_cos_f32 v106, v106
    v_cos_f32 v107, v107
    v_cvt_pk_bf16_f32 v98, v104, v105
    v_lshlrev_b32 v104, 16, v50
    v_and_b32 v105, s24, v50
    v_mul_f32 v104, v2, v104
    v_mul_f32 v105, v2, v105
    v_fract_f32 v104, v104
    v_fract_f32 v105, v105
    v_cos_f32 v104, v104
    v_cos_f32 v105, v105
    v_cvt_pk_bf16_f32 v99, v106, v107
    v_lshlrev_b32 v106, 16, v51
    v_and_b32 v107, s24, v51
    v_mul_f32 v106, v2, v106
    v_mul_f32 v107, v2, v107
    v_fract_f32 v106, v106
    v_fract_f32 v107, v107
    v_cos_f32 v106, v106
    v_cos_f32 v107, v107
    v_cvt_pk_bf16_f32 v100, v104, v105
    v_lshlrev_b32 v104, 16, v52
    v_and_b32 v105, s24, v52
    v_mul_f32 v104, v2, v104
    v_mul_f32 v105, v2, v105
    v_fract_f32 v104, v104
    v_fract_f32 v105, v105
    v_cos_f32 v104, v104
    v_cos_f32 v105, v105
    v_cvt_pk_bf16_f32 v101, v106, v107
    v_lshlrev_b32 v106, 16, v53
    v_and_b32 v107, s24, v53
    v_mul_f32 v106, v2, v106
    v_mul_f32 v107, v2, v107
    v_fract_f32 v106, v106
    v_fract_f32 v107, v107
    v_cos_f32 v106, v106
    v_cos_f32 v107, v107
    v_cvt_pk_bf16_f32 v102, v104, v105
    s_nop 0
    v_cvt_pk_bf16_f32 v103, v106, v107
    s_waitcnt lgkmcnt(0)
    v_or_b32 v74, v74, v24
    v_or_b32 v75, v75, v25
    v_or_b32 v76, v76, v26
    v_or_b32 v77, v77, v27
    v_or_b32 v78, v78, v28
    v_or_b32 v79, v79, v29
    v_or_b32 v80, v80, v30
    v_or_b32 v81, v81, v31
    v_or_b32 v82, v82, v32
    v_or_b32 v83, v83, v33
    v_or_b32 v84, v84, v34
    v_or_b32 v85, v85, v35
    v_or_b32 v86, v86, v36
    v_or_b32 v87, v87, v37
    v_or_b32 v88, v88, v38
    v_or_b32 v89, v89, v39
    v_or_b32 v90, v90, v40
    v_or_b32 v91, v91, v41
    v_or_b32 v92, v92, v42
    v_or_b32 v93, v93, v43
    s_barrier
    s_cmp_lg_u32 s28, 0
    s_cbranch_scc1 A_noscan
    v_lshlrev_b32 v24, 6, v0
    ds_read_b128 v[4:7], v24 offset:0
    ds_read_b128 v[8:11], v24 offset:16
    ds_read_b128 v[12:15], v24 offset:32
    ds_read_b128 v[16:19], v24 offset:48
    v_mov_b32 v20, 0
    v_mov_b32 v21, 0
    v_mov_b32 v22, 0
    v_mov_b32 v23, 0
    ds_write_b128 v24, v[20:23] offset:0
    ds_write_b128 v24, v[20:23] offset:16
    ds_write_b128 v24, v[20:23] offset:32
    ds_write_b128 v24, v[20:23] offset:48
    s_waitcnt lgkmcnt(4)
    v_mov_b32 v25, 0
    v_add_u32 v28, 1, v4
    v_and_b32 v28, -2, v28
    v_add_u32 v25, v25, v28
    v_add_u32 v28, 1, v5
    v_and_b32 v28, -2, v28
    v_add_u32 v25, v25, v28
    v_add_u32 v28, 1, v6
    v_and_b32 v28, -2, v28
    v_add_u32 v25, v25, v28
    v_add_u32 v28, 1, v7
    v_and_b32 v28, -2, v28
    v_add_u32 v25, v25, v28
    v_add_u32 v28, 1, v8
    v_and_b32 v28, -2, v28
    v_add_u32 v25, v25, v28
    v_add_u32 v28, 1, v9
    v_and_b32 v28, -2, v28
    v_add_u32 v25, v25, v28
    v_add_u32 v28, 1, v10
    v_and_b32 v28, -2, v28
    v_add_u32 v25, v25, v28
    v_add_u32 v28, 1, v11
    v_and_b32 v28, -2, v28
    v_add_u32 v25, v25, v28
    v_add_u32 v28, 1, v12
    v_and_b32 v28, -2, v28
    v_add_u32 v25, v25, v28
    v_add_u32 v28, 1, v13
    v_and_b32 v28, -2, v28
    v_add_u32 v25, v25, v28
    v_add_u32 v28, 1, v14
    v_and_b32 v28, -2, v28
    v_add_u32 v25, v25, v28
    v_add_u32 v28, 1, v15
    v_and_b32 v28, -2, v28
    v_add_u32 v25, v25, v28
    v_add_u32 v28, 1, v16
    v_and_b32 v28, -2, v28
    v_add_u32 v25, v25, v28
    v_add_u32 v28, 1, v17
    v_and_b32 v28, -2, v28
    v_add_u32 v25, v25, v28
    v_add_u32 v28, 1, v18
    v_and_b32 v28, -2, v28
    v_add_u32 v25, v25, v28
    v_add_u32 v28, 1, v19
    v_and_b32 v28, -2, v28
    v_add_u32 v25, v25, v28
    v_mul_u32_u24 v25, 6, v25
    v_mov_b32 v26, v25
    s_nop 1
    v_add_u32_dpp v26, v26, v26 row_shr:1 row_mask:0xf bank_mask:0xf
    s_nop 1
    v_add_u32_dpp v26, v26, v26 row_shr:2 row_mask:0xf bank_mask:0xf
    s_nop 1
    v_add_u32_dpp v26, v26, v26 row_shr:4 row_mask:0xf bank_mask:0xf
    s_nop 1
    v_add_u32_dpp v26, v26, v26 row_shr:8 row_mask:0xf bank_mask:0xf
    s_nop 1
    v_add_u32_dpp v26, v26, v26 row_bcast:15 row_mask:0xa bank_mask:0xf
    s_nop 1
    v_add_u32_dpp v26, v26, v26 row_bcast:31 row_mask:0xc bank_mask:0xf
    v_lshlrev_b32 v28, 2, v0
    ds_write_b32 v28, v26 offset:8192
    v_sub_u32 v27, v26, v25
    v_add_u32 v27, 4096, v27
    v_mov_b32 v30, -1
    v_and_b32 v31, 15, v0
    v_lshlrev_b32 v31, 8, v31
    v_lshrrev_b32 v28, 4, v0
    v_lshl_add_u32 v31, v28, 2, v31
    v_add_u32 v20, 8704, v27
    v_lshrrev_b32 v28, 1, v4
    v_mad_u32_u24 v28, v28, 12, v20
    ds_write_b32 v28, v30 offset:4
    v_add_u32 v29, 1, v4
    v_and_b32 v29, -2, v29
    v_lshrrev_b32 v28, 2, v27
    v_lshl_or_b32 v4, v4, 16, v28
    v_mad_u32_u24 v27, v29, 6, v27
    v_add_u32 v21, 8704, v27
    v_lshrrev_b32 v28, 1, v5
    v_mad_u32_u24 v28, v28, 12, v21
    ds_write_b32 v28, v30 offset:4
    v_add_u32 v29, 1, v5
    v_and_b32 v29, -2, v29
    v_lshrrev_b32 v28, 2, v27
    v_lshl_or_b32 v5, v5, 16, v28
    v_mad_u32_u24 v27, v29, 6, v27
    v_add_u32 v22, 8704, v27
    v_lshrrev_b32 v28, 1, v6
    v_mad_u32_u24 v28, v28, 12, v22
    ds_write_b32 v28, v30 offset:4
    v_add_u32 v29, 1, v6
    v_and_b32 v29, -2, v29
    v_lshrrev_b32 v28, 2, v27
    v_lshl_or_b32 v6, v6, 16, v28
    v_mad_u32_u24 v27, v29, 6, v27
    v_add_u32 v23, 8704, v27
    v_lshrrev_b32 v28, 1, v7
    v_mad_u32_u24 v28, v28, 12, v23
    ds_write_b32 v28, v30 offset:4
    v_add_u32 v29, 1, v7
    v_and_b32 v29, -2, v29
    v_lshrrev_b32 v28, 2, v27
    v_lshl_or_b32 v7, v7, 16, v28
    v_mad_u32_u24 v27, v29, 6, v27
    ds_write_b128 v24, v[20:23] offset:4096
    ds_write_b32 v31, v4 offset:8704
    ds_write_b32 v31, v5 offset:8720
    ds_write_b32 v31, v6 offset:8736
    ds_write_b32 v31, v7 offset:8752
    v_add_u32 v20, 8704, v27
    v_lshrrev_b32 v28, 1, v8
    v_mad_u32_u24 v28, v28, 12, v20
    ds_write_b32 v28, v30 offset:4
    v_add_u32 v29, 1, v8
    v_and_b32 v29, -2, v29
    v_lshrrev_b32 v28, 2, v27
    v_lshl_or_b32 v8, v8, 16, v28
    v_mad_u32_u24 v27, v29, 6, v27
    v_add_u32 v21, 8704, v27
    v_lshrrev_b32 v28, 1, v9
    v_mad_u32_u24 v28, v28, 12, v21
    ds_write_b32 v28, v30 offset:4
    v_add_u32 v29, 1, v9
    v_and_b32 v29, -2, v29
    v_lshrrev_b32 v28, 2, v27
    v_lshl_or_b32 v9, v9, 16, v28
    v_mad_u32_u24 v27, v29, 6, v27
    v_add_u32 v22, 8704, v27
    v_lshrrev_b32 v28, 1, v10
    v_mad_u32_u24 v28, v28, 12, v22
    ds_write_b32 v28, v30 offset:4
    v_add_u32 v29, 1, v10
    v_and_b32 v29, -2, v29
    v_lshrrev_b32 v28, 2, v27
    v_lshl_or_b32 v10, v10, 16, v28
    v_mad_u32_u24 v27, v29, 6, v27
    v_add_u32 v23, 8704, v27
    v_lshrrev_b32 v28, 1, v11
    v_mad_u32_u24 v28, v28, 12, v23
    ds_write_b32 v28, v30 offset:4
    v_add_u32 v29, 1, v11
    v_and_b32 v29, -2, v29
    v_lshrrev_b32 v28, 2, v27
    v_lshl_or_b32 v11, v11, 16, v28
    v_mad_u32_u24 v27, v29, 6, v27
    ds_write_b128 v24, v[20:23] offset:4112
    ds_write_b32 v31, v8 offset:8768
    ds_write_b32 v31, v9 offset:8784
    ds_write_b32 v31, v10 offset:8800
    ds_write_b32 v31, v11 offset:8816
    v_add_u32 v20, 8704, v27
    v_lshrrev_b32 v28, 1, v12
    v_mad_u32_u24 v28, v28, 12, v20
    ds_write_b32 v28, v30 offset:4
    v_add_u32 v29, 1, v12
    v_and_b32 v29, -2, v29
    v_lshrrev_b32 v28, 2, v27
    v_lshl_or_b32 v12, v12, 16, v28
    v_mad_u32_u24 v27, v29, 6, v27
    v_add_u32 v21, 8704, v27
    v_lshrrev_b32 v28, 1, v13
    v_mad_u32_u24 v28, v28, 12, v21
    ds_write_b32 v28, v30 offset:4
    v_add_u32 v29, 1, v13
    v_and_b32 v29, -2, v29
    v_lshrrev_b32 v28, 2, v27
    v_lshl_or_b32 v13, v13, 16, v28
    v_mad_u32_u24 v27, v29, 6, v27
    v_add_u32 v22, 8704, v27
    v_lshrrev_b32 v28, 1, v14
    v_mad_u32_u24 v28, v28, 12, v22
    ds_write_b32 v28, v30 offset:4
    v_add_u32 v29, 1, v14
    v_and_b32 v29, -2, v29
    v_lshrrev_b32 v28, 2, v27
    v_lshl_or_b32 v14, v14, 16, v28
    v_mad_u32_u24 v27, v29, 6, v27
    v_add_u32 v23, 8704, v27
    v_lshrrev_b32 v28, 1, v15
    v_mad_u32_u24 v28, v28, 12, v23
    ds_write_b32 v28, v30 offset:4
    v_add_u32 v29, 1, v15
    v_and_b32 v29, -2, v29
    v_lshrrev_b32 v28, 2, v27
    v_lshl_or_b32 v15, v15, 16, v28
    v_mad_u32_u24 v27, v29, 6, v27
    ds_write_b128 v24, v[20:23] offset:4128
    ds_write_b32 v31, v12 offset:8832
    ds_write_b32 v31, v13 offset:8848
    ds_write_b32 v31, v14 offset:8864
    ds_write_b32 v31, v15 offset:8880
    v_add_u32 v20, 8704, v27
    v_lshrrev_b32 v28, 1, v16
    v_mad_u32_u24 v28, v28, 12, v20
    ds_write_b32 v28, v30 offset:4
    v_add_u32 v29, 1, v16
    v_and_b32 v29, -2, v29
    v_lshrrev_b32 v28, 2, v27
    v_lshl_or_b32 v16, v16, 16, v28
    v_mad_u32_u24 v27, v29, 6, v27
    v_add_u32 v21, 8704, v27
    v_lshrrev_b32 v28, 1, v17
    v_mad_u32_u24 v28, v28, 12, v21
    ds_write_b32 v28, v30 offset:4
    v_add_u32 v29, 1, v17
    v_and_b32 v29, -2, v29
    v_lshrrev_b32 v28, 2, v27
    v_lshl_or_b32 v17, v17, 16, v28
    v_mad_u32_u24 v27, v29, 6, v27
    v_add_u32 v22, 8704, v27
    v_lshrrev_b32 v28, 1, v18
    v_mad_u32_u24 v28, v28, 12, v22
    ds_write_b32 v28, v30 offset:4
    v_add_u32 v29, 1, v18
    v_and_b32 v29, -2, v29
    v_lshrrev_b32 v28, 2, v27
    v_lshl_or_b32 v18, v18, 16, v28
    v_mad_u32_u24 v27, v29, 6, v27
    v_add_u32 v23, 8704, v27
    v_lshrrev_b32 v28, 1, v19
    v_mad_u32_u24 v28, v28, 12, v23
    ds_write_b32 v28, v30 offset:4
    v_add_u32 v29, 1, v19
    v_and_b32 v29, -2, v29
    v_lshrrev_b32 v28, 2, v27
    v_lshl_or_b32 v19, v19, 16, v28
    v_mad_u32_u24 v27, v29, 6, v27
    ds_write_b128 v24, v[20:23] offset:4144
    ds_write_b32 v31, v16 offset:8896
    ds_write_b32 v31, v17 offset:8912
    ds_write_b32 v31, v18 offset:8928
    ds_write_b32 v31, v19 offset:8944
    s_waitcnt lgkmcnt(0)
A_noscan:
    s_add_u32 s29, s25, 256
    s_mul_i32 s31, s29, 81920
    v_add_u32 v126, s31, v1
    buffer_load_dwordx4 v[4:7], v126, s[4:7], 0 offen nt
    buffer_load_dwordx4 v[24:27], v126, s[8:11], 0 offen nt
    v_lshrrev_b32 v105, 1, v126
    buffer_load_dwordx2 v[44:45], v105, s[12:15], 0 offen nt
    s_barrier
    v_lshrrev_b32 v124, 16, v74
    ds_read_b32 v104, v124 offset:4096
    v_lshrrev_b32 v125, 16, v75
    ds_read_b32 v105, v125 offset:4096
    v_lshrrev_b32 v124, 16, v76
    ds_read_b32 v106, v124 offset:4096
    v_lshrrev_b32 v125, 16, v77
    ds_read_b32 v107, v125 offset:4096
    v_lshrrev_b32 v124, 16, v78
    ds_read_b32 v108, v124 offset:4096
    v_lshrrev_b32 v125, 16, v79
    ds_read_b32 v109, v125 offset:4096
    v_lshrrev_b32 v124, 16, v80
    ds_read_b32 v110, v124 offset:4096
    v_lshrrev_b32 v125, 16, v81
    ds_read_b32 v111, v125 offset:4096
    v_lshrrev_b32 v124, 16, v82
    ds_read_b32 v112, v124 offset:4096
    v_lshrrev_b32 v125, 16, v83
    ds_read_b32 v113, v125 offset:4096
    v_lshrrev_b32 v124, 16, v84
    ds_read_b32 v114, v124 offset:4096
    v_lshrrev_b32 v125, 16, v85
    ds_read_b32 v115, v125 offset:4096
    v_lshrrev_b32 v124, 16, v86
    ds_read_b32 v116, v124 offset:4096
    v_lshrrev_b32 v125, 16, v87
    ds_read_b32 v117, v125 offset:4096
    v_lshrrev_b32 v124, 16, v88
    ds_read_b32 v118, v124 offset:4096
    v_lshrrev_b32 v125, 16, v89
    ds_read_b32 v119, v125 offset:4096
    v_lshrrev_b32 v124, 16, v90
    ds_read_b32 v120, v124 offset:4096
    v_lshrrev_b32 v125, 16, v91
    ds_read_b32 v121, v125 offset:4096
    v_lshrrev_b32 v124, 16, v92
    ds_read_b32 v122, v124 offset:4096
    v_lshrrev_b32 v125, 16, v93
    ds_read_b32 v123, v125 offset:4096
    v_mov_b32 v124, 8444
    ds_read_b32 v125, v124
    v_and_b32 v74, 0xffff, v74
    v_and_b32 v75, 0xffff, v75
    v_and_b32 v76, 0xffff, v76
    v_and_b32 v77, 0xffff, v77
    v_and_b32 v78, 0xffff, v78
    v_and_b32 v79, 0xffff, v79
    v_and_b32 v80, 0xffff, v80
    v_and_b32 v81, 0xffff, v81
    v_and_b32 v82, 0xffff, v82
    v_and_b32 v83, 0xffff, v83
    v_and_b32 v84, 0xffff, v84
    v_and_b32 v85, 0xffff, v85
    v_and_b32 v86, 0xffff, v86
    v_and_b32 v87, 0xffff, v87
    v_and_b32 v88, 0xffff, v88
    v_and_b32 v89, 0xffff, v89
    v_and_b32 v90, 0xffff, v90
    v_and_b32 v91, 0xffff, v91
    v_and_b32 v92, 0xffff, v92
    v_and_b32 v93, 0xffff, v93
    s_waitcnt lgkmcnt(0)
    v_readfirstlane_b32 s26, v125
    v_lshrrev_b32 v124, 1, v74
    v_and_b32 v74, 1, v74
    v_mad_u32_u24 v104, v124, 12, v104
    v_lshl_add_u32 v124, v74, 2, v104
    v_lshl_add_u32 v125, v74, 1, v104
    ds_write_b32 v124, v54
    ds_write_b16 v125, v94 offset:8
    v_lshrrev_b32 v124, 1, v75
    v_and_b32 v75, 1, v75
    v_mad_u32_u24 v105, v124, 12, v105
    v_lshl_add_u32 v124, v75, 2, v105
    v_lshl_add_u32 v125, v75, 1, v105
    ds_write_b32 v124, v55
    ds_write_b16_d16_hi v125, v94 offset:8
    v_lshrrev_b32 v124, 1, v76
    v_and_b32 v76, 1, v76
    v_mad_u32_u24 v106, v124, 12, v106
    v_lshl_add_u32 v124, v76, 2, v106
    v_lshl_add_u32 v125, v76, 1, v106
    ds_write_b32 v124, v56
    ds_write_b16 v125, v95 offset:8
    v_lshrrev_b32 v124, 1, v77
    v_and_b32 v77, 1, v77
    v_mad_u32_u24 v107, v124, 12, v107
    v_lshl_add_u32 v124, v77, 2, v107
    v_lshl_add_u32 v125, v77, 1, v107
    ds_write_b32 v124, v57
    ds_write_b16_d16_hi v125, v95 offset:8
    v_add_u32 v76, 16384, v126
    buffer_load_dwordx4 v[8:11], v76, s[4:7], 0 offen nt
    buffer_load_dwordx4 v[28:31], v76, s[8:11], 0 offen nt
    v_lshrrev_b32 v77, 1, v76
    buffer_load_dwordx2 v[46:47], v77, s[12:15], 0 offen nt
    v_lshrrev_b32 v124, 1, v78
    v_and_b32 v78, 1, v78
    v_mad_u32_u24 v108, v124, 12, v108
    v_lshl_add_u32 v124, v78, 2, v108
    v_lshl_add_u32 v125, v78, 1, v108
    ds_write_b32 v124, v58
    ds_write_b16 v125, v96 offset:8
    v_lshrrev_b32 v124, 1, v79
    v_and_b32 v79, 1, v79
    v_mad_u32_u24 v109, v124, 12, v109
    v_lshl_add_u32 v124, v79, 2, v109
    v_lshl_add_u32 v125, v79, 1, v109
    ds_write_b32 v124, v59
    ds_write_b16_d16_hi v125, v96 offset:8
    v_lshrrev_b32 v124, 1, v80
    v_and_b32 v80, 1, v80
    v_mad_u32_u24 v110, v124, 12, v110
    v_lshl_add_u32 v124, v80, 2, v110
    v_lshl_add_u32 v125, v80, 1, v110
    ds_write_b32 v124, v60
    ds_write_b16 v125, v97 offset:8
    v_lshrrev_b32 v124, 1, v81
    v_and_b32 v81, 1, v81
    v_mad_u32_u24 v111, v124, 12, v111
    v_lshl_add_u32 v124, v81, 2, v111
    v_lshl_add_u32 v125, v81, 1, v111
    ds_write_b32 v124, v61
    ds_write_b16_d16_hi v125, v97 offset:8
    v_add_u32 v80, 32768, v126
    buffer_load_dwordx4 v[12:15], v80, s[4:7], 0 offen nt
    buffer_load_dwordx4 v[32:35], v80, s[8:11], 0 offen nt
    v_lshrrev_b32 v81, 1, v80
    buffer_load_dwordx2 v[48:49], v81, s[12:15], 0 offen nt
    v_lshrrev_b32 v124, 1, v82
    v_and_b32 v82, 1, v82
    v_mad_u32_u24 v112, v124, 12, v112
    v_lshl_add_u32 v124, v82, 2, v112
    v_lshl_add_u32 v125, v82, 1, v112
    ds_write_b32 v124, v62
    ds_write_b16 v125, v98 offset:8
    v_lshrrev_b32 v124, 1, v83
    v_and_b32 v83, 1, v83
    v_mad_u32_u24 v113, v124, 12, v113
    v_lshl_add_u32 v124, v83, 2, v113
    v_lshl_add_u32 v125, v83, 1, v113
    ds_write_b32 v124, v63
    ds_write_b16_d16_hi v125, v98 offset:8
    v_lshrrev_b32 v124, 1, v84
    v_and_b32 v84, 1, v84
    v_mad_u32_u24 v114, v124, 12, v114
    v_lshl_add_u32 v124, v84, 2, v114
    v_lshl_add_u32 v125, v84, 1, v114
    ds_write_b32 v124, v64
    ds_write_b16 v125, v99 offset:8
    v_lshrrev_b32 v124, 1, v85
    v_and_b32 v85, 1, v85
    v_mad_u32_u24 v115, v124, 12, v115
    v_lshl_add_u32 v124, v85, 2, v115
    v_lshl_add_u32 v125, v85, 1, v115
    ds_write_b32 v124, v65
    ds_write_b16_d16_hi v125, v99 offset:8
    v_add_u32 v84, 49152, v126
    buffer_load_dwordx4 v[16:19], v84, s[4:7], 0 offen nt
    buffer_load_dwordx4 v[36:39], v84, s[8:11], 0 offen nt
    v_lshrrev_b32 v85, 1, v84
    buffer_load_dwordx2 v[50:51], v85, s[12:15], 0 offen nt
    v_lshrrev_b32 v124, 1, v86
    v_and_b32 v86, 1, v86
    v_mad_u32_u24 v116, v124, 12, v116
    v_lshl_add_u32 v124, v86, 2, v116
    v_lshl_add_u32 v125, v86, 1, v116
    ds_write_b32 v124, v66
    ds_write_b16 v125, v100 offset:8
    v_lshrrev_b32 v124, 1, v87
    v_and_b32 v87, 1, v87
    v_mad_u32_u24 v117, v124, 12, v117
    v_lshl_add_u32 v124, v87, 2, v117
    v_lshl_add_u32 v125, v87, 1, v117
    ds_write_b32 v124, v67
    ds_write_b16_d16_hi v125, v100 offset:8
    v_lshrrev_b32 v124, 1, v88
    v_and_b32 v88, 1, v88
    v_mad_u32_u24 v118, v124, 12, v118
    v_lshl_add_u32 v124, v88, 2, v118
    v_lshl_add_u32 v125, v88, 1, v118
    ds_write_b32 v124, v68
    ds_write_b16 v125, v101 offset:8
    v_lshrrev_b32 v124, 1, v89
    v_and_b32 v89, 1, v89
    v_mad_u32_u24 v119, v124, 12, v119
    v_lshl_add_u32 v124, v89, 2, v119
    v_lshl_add_u32 v125, v89, 1, v119
    ds_write_b32 v124, v69
    ds_write_b16_d16_hi v125, v101 offset:8
    v_add_u32 v88, 65536, v126
    buffer_load_dwordx4 v[20:23], v88, s[4:7], 0 offen nt
    buffer_load_dwordx4 v[40:43], v88, s[8:11], 0 offen nt
    v_lshrrev_b32 v89, 1, v88
    buffer_load_dwordx2 v[52:53], v89, s[12:15], 0 offen nt
    v_lshrrev_b32 v124, 1, v90
    v_and_b32 v90, 1, v90
    v_mad_u32_u24 v120, v124, 12, v120
    v_lshl_add_u32 v124, v90, 2, v120
    v_lshl_add_u32 v125, v90, 1, v120
    ds_write_b32 v124, v70
    ds_write_b16 v125, v102 offset:8
    v_lshrrev_b32 v124, 1, v91
    v_and_b32 v91, 1, v91
    v_mad_u32_u24 v121, v124, 12, v121
    v_lshl_add_u32 v124, v91, 2, v121
    v_lshl_add_u32 v125, v91, 1, v121
    ds_write_b32 v124, v71
    ds_write_b16_d16_hi v125, v102 offset:8
    v_lshrrev_b32 v124, 1, v92
    v_and_b32 v92, 1, v92
    v_mad_u32_u24 v122, v124, 12, v122
    v_lshl_add_u32 v124, v92, 2, v122
    v_lshl_add_u32 v125, v92, 1, v122
    ds_write_b32 v124, v72
    ds_write_b16 v125, v103 offset:8
    v_lshrrev_b32 v124, 1, v93
    v_and_b32 v93, 1, v93
    v_mad_u32_u24 v123, v124, 12, v123
    v_lshl_add_u32 v124, v93, 2, v123
    v_lshl_add_u32 v125, v93, 1, v123
    ds_write_b32 v124, v73
    ds_write_b16_d16_hi v125, v103 offset:8
    s_add_u32 s26, s26, 4096
    s_mul_i32 s27, s25, 133120
    s_waitcnt lgkmcnt(0)
    s_barrier
    s_cmp_le_u32 s26, 131072
    s_cbranch_scc1 A_no9
    v_add_u32 v120, 131072, v1
    v_add_u32 v122, 8704, v120
    v_cmp_gt_u32 vcc, s26, v120
    s_and_saveexec_b64 s[38:39], vcc
    ds_read_b128 v[112:115], v122
    s_waitcnt lgkmcnt(0)
    buffer_store_dwordx4 v[112:115], v120, s[20:23], s27 offen sc1
    s_mov_b64 exec, s[38:39]
    s_nop 1
A_no9:
    s_waitcnt vmcnt(0)
    s_add_u32 s25, s25, 256
    s_cmp_lt_u32 s25, 1250
    s_cbranch_scc1 A_tile
    v_add_u32 v104, 0, v1
    v_cmp_gt_u32 s[40:41], s26, v104
    v_add_u32 v105, 16384, v1
    v_cmp_gt_u32 s[42:43], s26, v105
    v_add_u32 v106, 32768, v1
    v_cmp_gt_u32 s[44:45], s26, v106
    v_add_u32 v107, 49152, v1
    v_cmp_gt_u32 s[46:47], s26, v107
    v_add_u32 v108, 65536, v1
    v_cmp_gt_u32 s[48:49], s26, v108
    v_add_u32 v109, 81920, v1
    v_cmp_gt_u32 s[50:51], s26, v109
    v_add_u32 v110, 98304, v1
    v_cmp_gt_u32 s[52:53], s26, v110
    v_add_u32 v111, 114688, v1
    v_cmp_gt_u32 s[54:55], s26, v111
    v_add_u32 v114, 8704, v104
    s_mov_b64 exec, s[40:41]
    ds_read_b128 v[4:7], v114
    s_mov_b64 exec, -1
    v_add_u32 v115, 8704, v105
    s_mov_b64 exec, s[42:43]
    ds_read_b128 v[8:11], v115
    s_mov_b64 exec, -1
    v_add_u32 v114, 8704, v106
    s_mov_b64 exec, s[44:45]
    ds_read_b128 v[12:15], v114
    s_mov_b64 exec, -1
    v_add_u32 v115, 8704, v107
    s_mov_b64 exec, s[46:47]
    ds_read_b128 v[16:19], v115
    s_mov_b64 exec, -1
    v_add_u32 v114, 8704, v108
    s_mov_b64 exec, s[48:49]
    ds_read_b128 v[20:23], v114
    s_mov_b64 exec, -1
    v_add_u32 v115, 8704, v109
    s_mov_b64 exec, s[50:51]
    ds_read_b128 v[24:27], v115
    s_mov_b64 exec, -1
    v_add_u32 v114, 8704, v110
    s_mov_b64 exec, s[52:53]
    ds_read_b128 v[28:31], v114
    s_mov_b64 exec, -1
    v_add_u32 v115, 8704, v111
    s_mov_b64 exec, s[54:55]
    ds_read_b128 v[32:35], v115
    s_mov_b64 exec, -1
    s_waitcnt lgkmcnt(0)
    s_mov_b64 exec, s[40:41]
    buffer_store_dwordx4 v[4:7], v104, s[20:23], s27 offen sc1
    s_mov_b64 exec, s[42:43]
    buffer_store_dwordx4 v[8:11], v105, s[20:23], s27 offen sc1
    s_mov_b64 exec, s[44:45]
    buffer_store_dwordx4 v[12:15], v106, s[20:23], s27 offen sc1
    s_mov_b64 exec, s[46:47]
    buffer_store_dwordx4 v[16:19], v107, s[20:23], s27 offen sc1
    s_mov_b64 exec, s[48:49]
    buffer_store_dwordx4 v[20:23], v108, s[20:23], s27 offen sc1
    s_mov_b64 exec, s[50:51]
    buffer_store_dwordx4 v[24:27], v109, s[20:23], s27 offen sc1
    s_mov_b64 exec, s[52:53]
    buffer_store_dwordx4 v[28:31], v110, s[20:23], s27 offen sc1
    s_mov_b64 exec, s[54:55]
    buffer_store_dwordx4 v[32:35], v111, s[20:23], s27 offen sc1
    s_mov_b64 exec, -1
A_end:
    s_endpgm
.globl acc_kernel
.p2align 8
.type acc_kernel,@function
acc_kernel:
    s_cmp_ge_u32 s2, 256
    s_cbranch_scc1 P_end
    s_load_dwordx2 s[86:87], s[0:1], 0
    s_load_dwordx2 s[88:89], s[0:1], 104
    v_and_b32 v1, 63, v0
    v_lshrrev_b32 v110, 6, v0
    s_nop 0
    v_readfirstlane_b32 s16, v110
    s_and_b32 s17, s2, 7
    s_lshl_b32 s17, s17, 5
    s_lshr_b32 s23, s2, 3
    s_add_u32 s17, s17, s23
    s_mov_b32 s18, 0xffff0000
    s_waitcnt lgkmcnt(0)
    s_mov_b32 s8, s86
    s_and_b32 s9, s87, 0xffff
    s_mov_b32 s10, 6400000
    s_mov_b32 s11, 0x00020000
    s_mov_b32 s4, s88
    s_and_b32 s5, s89, 0xffff
    s_mov_b32 s6, 409600000
    s_mov_b32 s7, 0x00020000
    s_mov_b32 s12, s88
    s_and_b32 s13, s89, 0xffff
    s_mov_b32 s14, 166400000
    s_mov_b32 s15, 0x00020000
    v_lshlrev_b32 v110, 4, v1
    v_add_u32 v110, s16, v110
    s_mov_b32 s23, 133120
    v_mul_lo_u32 v110, v110, s23
    s_lshl_b32 s24, s17, 4
    v_add_u32 v110, s24, v110
    v_add_u32 v111, 136314880, v110
    buffer_load_dwordx4 v[6:9], v110, s[12:15], 0 offen
    buffer_load_dwordx4 v[10:13], v111, s[12:15], 0 offen
    v_lshlrev_b32 v112, 4, v1
    v_add_u32 v112, 166400000, v112
    buffer_load_dwordx4 v[114:117], v112, s[4:7], 0 offen
    buffer_load_dwordx4 v[118:121], v112, s[4:7], 0 offen offset:1024
    v_mov_b32 v3, s18
    v_mov_b32 v4, 1
    v_and_b32 v16, 15, v1
    v_mul_u32_u24 v14, 12, v16
    v_lshlrev_b32 v16, 1, v16
    v_lshrrev_b32 v17, 4, v1
    s_mul_i32 s26, s16, 133120
    s_mov_b32 s23, 2129920
    v_mul_lo_u32 v15, v17, s23
    v_add_u32 v15, s26, v15
    v_add_u32 v15, v14, v15
    v_lshlrev_b32 v17, 2, v17
    s_mov_b32 s33, 104000
    s_mov_b32 s78, 4092
    v_mov_b32 v82, 0
    v_mov_b32 v83, 0
    v_mov_b32 v84, 0
    v_mov_b32 v85, 0
    v_mov_b32 v86, 0
    v_mov_b32 v87, 0
    v_mov_b32 v88, 0
    v_mov_b32 v89, 0
    v_mov_b32 v90, 0
    v_mov_b32 v91, 0
    v_mov_b32 v92, 0
    v_mov_b32 v93, 0
    v_mov_b32 v94, 0
    v_mov_b32 v95, 0
    v_mov_b32 v96, 0
    v_mov_b32 v97, 0
    v_mov_b32 v98, 0
    v_mov_b32 v99, 0
    v_mov_b32 v100, 0
    v_mov_b32 v101, 0
    v_mov_b32 v102, 0
    v_mov_b32 v103, 0
    v_mov_b32 v104, 0
    v_mov_b32 v105, 0
    v_mov_b32 v106, 0
    v_mov_b32 v107, 0
    v_mov_b32 v108, 0
    v_mov_b32 v109, 0
    v_lshlrev_b32 v122, 3, v0
    v_add_u32 v122, 156000, v122
    v_cmp_gt_u32 vcc, 400, v0
    s_and_saveexec_b64 s[34:35], vcc
    ds_write_b64 v122, v[82:83]
    s_mov_b64 exec, s[34:35]
    s_waitcnt vmcnt(0) lgkmcnt(0)
    s_barrier
    v_max3_u32 v114, v114, v115, v116
    v_max_u32 v114, v114, v117
    s_nop 1
    v_max_u32_dpp v114, v114, v114 row_shr:1 row_mask:0xf bank_mask:0xf
    s_nop 1
    v_max_u32_dpp v114, v114, v114 row_shr:2 row_mask:0xf bank_mask:0xf
    s_nop 1
    v_max_u32_dpp v114, v114, v114 row_shr:4 row_mask:0xf bank_mask:0xf
    s_nop 1
    v_max_u32_dpp v114, v114, v114 row_shr:8 row_mask:0xf bank_mask:0xf
    s_nop 1
    v_max_u32_dpp v114, v114, v114 row_bcast:15 row_mask:0xa bank_mask:0xf
    s_nop 1
    v_max_u32_dpp v114, v114, v114 row_bcast:31 row_mask:0xc bank_mask:0xf
    v_add_f32 v118, v118, v119
    v_add_f32 v120, v120, v121
    v_add_f32 v118, v118, v120
    s_nop 1
    v_add_f32_dpp v118, v118, v118 row_shr:1 row_mask:0xf bank_mask:0xf
    s_nop 1
    v_add_f32_dpp v118, v118, v118 row_shr:2 row_mask:0xf bank_mask:0xf
    s_nop 1
    v_add_f32_dpp v118, v118, v118 row_shr:4 row_mask:0xf bank_mask:0xf
    s_nop 1
    v_add_f32_dpp v118, v118, v118 row_shr:8 row_mask:0xf bank_mask:0xf
    s_nop 1
    v_add_f32_dpp v118, v118, v118 row_bcast:15 row_mask:0xa bank_mask:0xf
    s_nop 1
    v_add_f32_dpp v118, v118, v118 row_bcast:31 row_mask:0xc bank_mask:0xf
    s_nop 1
    v_readlane_b32 s23, v114, 63
    v_readlane_b32 s24, v118, 63
    s_lshl_b32 s32, s23, 16
    s_lshr_b32 s23, s23, 7
    s_sub_u32 s30, 271, s23
    s_min_u32 s30, s30, 253
    s_lshl_b32 s19, s30, 23
    s_sub_u32 s30, 254, s30
    s_lshl_b32 s20, s30, 23
    s_sub_u32 s30, 283, s23
    s_min_u32 s30, s30, 253
    s_lshl_b32 s71, s30, 23
    s_sub_u32 s30, 254, s30
    s_lshl_b32 s72, s30, 23
    v_mov_b32 v2, s19
    v_mov_b32 v118, s32
    v_mul_f32 v118, 0x46800000, v118
    v_mov_b32 v119, s24
    v_cmp_nle_f32 vcc, v118, v119
    s_cmp_lg_u64 vcc, 0
    s_cselect_b32 s73, 1, 0
    s_cmp_eq_u32 s32, 0
    s_cselect_b32 s73, 0, s73
    s_mov_b32 s69, 0x08000000
    s_and_b32 s70, s17, 1
    s_mul_i32 s70, s70, 800000
    s_mov_b32 s27, 0
    v_lshrrev_b32 v118, 16, v6
    v_lshrrev_b32 v119, 16, v10
    v_add_u32 v118, v118, v119
    s_nop 1
    v_add_u32_dpp v118, v118, v118 row_shr:1 row_mask:0xf bank_mask:0xf
    s_nop 1
    v_add_u32_dpp v118, v118, v118 row_shr:2 row_mask:0xf bank_mask:0xf
    s_nop 1
    v_add_u32_dpp v118, v118, v118 row_shr:4 row_mask:0xf bank_mask:0xf
    s_nop 1
    v_add_u32_dpp v118, v118, v118 row_shr:8 row_mask:0xf bank_mask:0xf
    s_nop 1
    v_add_u32_dpp v118, v118, v118 row_bcast:15 row_mask:0xa bank_mask:0xf
    s_nop 1
    v_add_u32_dpp v118, v118, v118 row_bcast:31 row_mask:0xc bank_mask:0xf
    v_mov_b32 v119, 159136
    s_mov_b32 exec_lo, 0
    s_mov_b32 exec_hi, 0x80000000
    ds_add_u32 v119, v118
    s_mov_b64 exec, -1
    v_lshrrev_b32 v118, 16, v7
    v_lshrrev_b32 v119, 16, v11
    v_add_u32 v118, v118, v119
    s_nop 1
    v_add_u32_dpp v118, v118, v118 row_shr:1 row_mask:0xf bank_mask:0xf
    s_nop 1
    v_add_u32_dpp v118, v118, v118 row_shr:2 row_mask:0xf bank_mask:0xf
    s_nop 1
    v_add_u32_dpp v118, v118, v118 row_shr:4 row_mask:0xf bank_mask:0xf
    s_nop 1
    v_add_u32_dpp v118, v118, v118 row_shr:8 row_mask:0xf bank_mask:0xf
    s_nop 1
    v_add_u32_dpp v118, v118, v118 row_bcast:15 row_mask:0xa bank_mask:0xf
    s_nop 1
    v_add_u32_dpp v118, v118, v118 row_bcast:31 row_mask:0xc bank_mask:0xf
    v_mov_b32 v119, 159140
    s_mov_b32 exec_lo, 0
    s_mov_b32 exec_hi, 0x80000000
    ds_add_u32 v119, v118
    s_mov_b64 exec, -1
    v_lshrrev_b32 v118, 16, v8
    v_lshrrev_b32 v119, 16, v12
    v_add_u32 v118, v118, v119
    s_nop 1
    v_add_u32_dpp v118, v118, v118 row_shr:1 row_mask:0xf bank_mask:0xf
    s_nop 1
    v_add_u32_dpp v118, v118, v118 row_shr:2 row_mask:0xf bank_mask:0xf
    s_nop 1
    v_add_u32_dpp v118, v118, v118 row_shr:4 row_mask:0xf bank_mask:0xf
    s_nop 1
    v_add_u32_dpp v118, v118, v118 row_shr:8 row_mask:0xf bank_mask:0xf
    s_nop 1
    v_add_u32_dpp v118, v118, v118 row_bcast:15 row_mask:0xa bank_mask:0xf
    s_nop 1
    v_add_u32_dpp v118, v118, v118 row_bcast:31 row_mask:0xc bank_mask:0xf
    v_mov_b32 v119, 159144
    s_mov_b32 exec_lo, 0
    s_mov_b32 exec_hi, 0x80000000
    ds_add_u32 v119, v118
    s_mov_b64 exec, -1
    v_lshrrev_b32 v118, 16, v9
    v_lshrrev_b32 v119, 16, v13
    v_add_u32 v118, v118, v119
    s_nop 1
    v_add_u32_dpp v118, v118, v118 row_shr:1 row_mask:0xf bank_mask:0xf
    s_nop 1
    v_add_u32_dpp v118, v118, v118 row_shr:2 row_mask:0xf bank_mask:0xf
    s_nop 1
    v_add_u32_dpp v118, v118, v118 row_shr:4 row_mask:0xf bank_mask:0xf
    s_nop 1
    v_add_u32_dpp v118, v118, v118 row_shr:8 row_mask:0xf bank_mask:0xf
    s_nop 1
    v_add_u32_dpp v118, v118, v118 row_bcast:15 row_mask:0xa bank_mask:0xf
    s_nop 1
    v_add_u32_dpp v118, v118, v118 row_bcast:31 row_mask:0xc bank_mask:0xf
    v_mov_b32 v119, 159148
    s_mov_b32 exec_lo, 0
    s_mov_b32 exec_hi, 0x80000000
    ds_add_u32 v119, v118
    s_mov_b64 exec, -1
    s_waitcnt lgkmcnt(0)
    s_barrier
    v_mov_b32 v118, 159136
    ds_read_b128 v[120:123], v118
    s_waitcnt lgkmcnt(0)
    v_readfirstlane_b32 s36, v120
    v_readfirstlane_b32 s37, v121
    v_readfirstlane_b32 s38, v122
    v_readfirstlane_b32 s39, v123
    s_mov_b32 s68, 0
    s_cmp_gt_u32 s36, 26000
    s_cselect_b32 s73, 1, s73
    s_add_u32 s68, s68, s36
    s_cmp_gt_u32 s37, 26000
    s_cselect_b32 s73, 1, s73
    s_add_u32 s68, s68, s37
    s_cmp_gt_u32 s38, 26000
    s_cselect_b32 s73, 1, s73
    s_add_u32 s68, s68, s38
    s_cmp_gt_u32 s39, 26000
    s_cselect_b32 s73, 1, s73
    s_add_u32 s68, s68, s39
    s_mov_b32 s66, 4
    s_mov_b32 s67, 0
    s_mov_b32 s25, s70
    s_cmp_lg_u32 s73, 0
    s_cbranch_scc1 P_robust
    s_mov_b64 s[74:75], -1
    v_add_u32 v127, 208, v17
    ds_bpermute_b32 v57, v127, v6
    v_mov_b32 v58, -1
    v_mov_b32 v59, -1
    v_add_u32 v126, 224, v17
    ds_bpermute_b32 v74, v126, v6
    v_mov_b32 v60, -1
    v_mov_b32 v61, -1
    v_add_u32 v127, 240, v17
    ds_bpermute_b32 v75, v127, v6
    v_mov_b32 v62, -1
    v_mov_b32 v63, -1
    v_add_u32 v126, 0, v17
    ds_bpermute_b32 v76, v126, v10
    v_mov_b32 v64, -1
    v_mov_b32 v65, -1
    v_add_u32 v127, 16, v17
    ds_bpermute_b32 v77, v127, v10
    v_mov_b32 v66, -1
    v_mov_b32 v67, -1
    v_add_u32 v126, 32, v17
    ds_bpermute_b32 v78, v126, v10
    v_mov_b32 v68, -1
    v_mov_b32 v69, -1
    v_add_u32 v127, 48, v17
    ds_bpermute_b32 v79, v127, v10
    v_mov_b32 v70, -1
    v_mov_b32 v71, -1
    s_waitcnt lgkmcnt(0)
    v_lshrrev_b32 v115, 16, v57
    v_and_b32 v116, 0xffff, v57
    v_add_u32 v117, 110755840, v15
    v_cmp_gt_u32 s[42:43], v115, v16
    v_lshl_add_u32 v117, v116, 2, v117
    s_and_b64 exec, s[42:43], s[74:75]
    buffer_load_dwordx2 v[58:59], v117, s[4:7], 0 offen
    buffer_load_dword v57, v117, s[4:7], 0 offen offset:8
    s_mov_b64 exec, -1
    v_lshrrev_b32 v112, 16, v74
    v_and_b32 v113, 0xffff, v74
    v_add_u32 v114, 119275520, v15
    v_cmp_gt_u32 s[40:41], v112, v16
    v_lshl_add_u32 v114, v113, 2, v114
    s_and_b64 exec, s[40:41], s[74:75]
    buffer_load_dwordx2 v[60:61], v114, s[4:7], 0 offen
    buffer_load_dword v74, v114, s[4:7], 0 offen offset:8
    s_mov_b64 exec, -1
    v_lshrrev_b32 v115, 16, v75
    v_and_b32 v116, 0xffff, v75
    v_add_u32 v117, 127795200, v15
    v_cmp_gt_u32 s[42:43], v115, v16
    v_lshl_add_u32 v117, v116, 2, v117
    s_and_b64 exec, s[42:43], s[74:75]
    buffer_load_dwordx2 v[62:63], v117, s[4:7], 0 offen
    buffer_load_dword v75, v117, s[4:7], 0 offen offset:8
    s_mov_b64 exec, -1
    v_lshrrev_b32 v112, 16, v76
    v_and_b32 v113, 0xffff, v76
    v_add_u32 v114, 136314880, v15
    v_cmp_gt_u32 s[40:41], v112, v16
    v_lshl_add_u32 v114, v113, 2, v114
    s_and_b64 exec, s[40:41], s[74:75]
    buffer_load_dwordx2 v[64:65], v114, s[4:7], 0 offen
    buffer_load_dword v76, v114, s[4:7], 0 offen offset:8
    s_mov_b64 exec, -1
    v_lshrrev_b32 v115, 16, v77
    v_and_b32 v116, 0xffff, v77
    v_add_u32 v117, 144834560, v15
    v_cmp_gt_u32 s[42:43], v115, v16
    v_lshl_add_u32 v117, v116, 2, v117
    s_and_b64 exec, s[42:43], s[74:75]
    buffer_load_dwordx2 v[66:67], v117, s[4:7], 0 offen
    buffer_load_dword v77, v117, s[4:7], 0 offen offset:8
    s_mov_b64 exec, -1
    v_lshrrev_b32 v112, 16, v78
    v_and_b32 v113, 0xffff, v78
    v_add_u32 v114, 153354240, v15
    v_cmp_gt_u32 s[40:41], v112, v16
    v_lshl_add_u32 v114, v113, 2, v114
    s_and_b64 exec, s[40:41], s[74:75]
    buffer_load_dwordx2 v[68:69], v114, s[4:7], 0 offen
    buffer_load_dword v78, v114, s[4:7], 0 offen offset:8
    s_mov_b64 exec, -1
    v_lshrrev_b32 v115, 16, v79
    v_and_b32 v116, 0xffff, v79
    v_add_u32 v117, 161873920, v15
    v_cmp_gt_u32 s[42:43], v115, v16
    v_lshl_add_u32 v117, v116, 2, v117
    s_and_b64 exec, s[42:43], s[74:75]
    buffer_load_dwordx2 v[70:71], v117, s[4:7], 0 offen
    buffer_load_dword v79, v117, s[4:7], 0 offen offset:8
    s_mov_b64 exec, -1
    v_mov_b32 v72, -1
    v_mov_b32 v73, -1
    v_mov_b32 v110, 0
    v_mov_b32 v111, 0
    s_mov_b32 s28, 0
    v_lshrrev_b32 v112, 16, v6
    v_cmp_lt_u32 s[64:65], 32, v112
P_ov1_0:
    s_cmp_eq_u64 s[64:65], 0
    s_cbranch_scc1 P_ov1_0_done
    s_cmp_ge_u32 s28, 4
    s_cbranch_scc1 P_ov1_0_done
    s_ff1_i32_b64 s23, s[64:65]
    s_bitset0_b64 s[64:65], s23
    v_readlane_b32 s32, v6, s23
    s_add_u32 s23, s23, 0
    s_mul_i32 s23, s23, 2129920
    s_add_u32 s23, s23, s26
    s_and_b32 s24, s32, 0xffff
    s_lshl_b32 s24, s24, 2
    s_add_u32 s23, s23, s24
    s_add_u32 s23, s23, 192
    s_lshr_b32 s32, s32, 16
    s_sub_u32 s32, s32, 32
    s_lshl_b32 s24, s28, 4
    s_lshl_b64 exec, 0xffff, s24
    v_mov_b32 v110, s32
    v_add_u32 v111, s23, v14
    s_mov_b64 exec, -1
    s_add_u32 s28, s28, 1
    s_branch P_ov1_0
P_ov1_0_done:
    v_lshrrev_b32 v112, 16, v10
    v_cmp_lt_u32 s[64:65], 32, v112
P_ov1_1:
    s_cmp_eq_u64 s[64:65], 0
    s_cbranch_scc1 P_ov1_1_done
    s_cmp_ge_u32 s28, 4
    s_cbranch_scc1 P_ov1_1_done
    s_ff1_i32_b64 s23, s[64:65]
    s_bitset0_b64 s[64:65], s23
    v_readlane_b32 s32, v10, s23
    s_add_u32 s23, s23, 64
    s_mul_i32 s23, s23, 2129920
    s_add_u32 s23, s23, s26
    s_and_b32 s24, s32, 0xffff
    s_lshl_b32 s24, s24, 2
    s_add_u32 s23, s23, s24
    s_add_u32 s23, s23, 192
    s_lshr_b32 s32, s32, 16
    s_sub_u32 s32, s32, 32
    s_lshl_b32 s24, s28, 4
    s_lshl_b64 exec, 0xffff, s24
    v_mov_b32 v110, s32
    v_add_u32 v111, s23, v14
    s_mov_b64 exec, -1
    s_add_u32 s28, s28, 1
    s_branch P_ov1_1
P_ov1_1_done:
    v_cmp_gt_u32 s[44:45], v110, v16
    s_and_b64 exec, s[44:45], s[74:75]
    buffer_load_dwordx2 v[72:73], v111, s[4:7], 0 offen
    buffer_load_dword v80, v111, s[4:7], 0 offen offset:8
    s_mov_b64 exec, -1
    s_mov_b32 s67, 2
    v_add_u32 v126, 0, v17
    ds_bpermute_b32 v44, v126, v6
    v_mov_b32 v18, -1
    v_mov_b32 v19, -1
    v_add_u32 v127, 16, v17
    ds_bpermute_b32 v45, v127, v6
    v_mov_b32 v20, -1
    v_mov_b32 v21, -1
    v_add_u32 v126, 32, v17
    ds_bpermute_b32 v46, v126, v6
    v_mov_b32 v22, -1
    v_mov_b32 v23, -1
    v_add_u32 v127, 48, v17
    ds_bpermute_b32 v47, v127, v6
    v_mov_b32 v24, -1
    v_mov_b32 v25, -1
    v_add_u32 v126, 64, v17
    ds_bpermute_b32 v48, v126, v6
    v_mov_b32 v26, -1
    v_mov_b32 v27, -1
    v_add_u32 v127, 80, v17
    ds_bpermute_b32 v49, v127, v6
    v_mov_b32 v28, -1
    v_mov_b32 v29, -1
    v_add_u32 v126, 96, v17
    ds_bpermute_b32 v50, v126, v6
    v_mov_b32 v30, -1
    v_mov_b32 v31, -1
    v_add_u32 v127, 112, v17
    ds_bpermute_b32 v51, v127, v6
    v_mov_b32 v32, -1
    v_mov_b32 v33, -1
    v_add_u32 v126, 128, v17
    ds_bpermute_b32 v52, v126, v6
    v_mov_b32 v34, -1
    v_mov_b32 v35, -1
    v_add_u32 v127, 144, v17
    ds_bpermute_b32 v53, v127, v6
    v_mov_b32 v36, -1
    v_mov_b32 v37, -1
    v_add_u32 v126, 160, v17
    ds_bpermute_b32 v54, v126, v6
    v_mov_b32 v38, -1
    v_mov_b32 v39, -1
    v_add_u32 v127, 176, v17
    ds_bpermute_b32 v55, v127, v6
    v_mov_b32 v40, -1
    v_mov_b32 v41, -1
    v_add_u32 v126, 192, v17
    ds_bpermute_b32 v56, v126, v6
    v_mov_b32 v42, -1
    v_mov_b32 v43, -1
    s_waitcnt lgkmcnt(0)
    v_lshrrev_b32 v112, 16, v44
    v_and_b32 v113, 0xffff, v44
    v_add_u32 v114, 0, v15
    v_cmp_gt_u32 s[40:41], v112, v16
    v_lshl_add_u32 v114, v113, 2, v114
    s_and_b64 exec, s[40:41], s[74:75]
    buffer_load_dwordx2 v[18:19], v114, s[4:7], 0 offen
    buffer_load_dword v44, v114, s[4:7], 0 offen offset:8
    s_mov_b64 exec, -1
    v_lshrrev_b32 v115, 16, v45
    v_and_b32 v116, 0xffff, v45
    v_add_u32 v117, 8519680, v15
    v_cmp_gt_u32 s[42:43], v115, v16
    v_lshl_add_u32 v117, v116, 2, v117
    s_and_b64 exec, s[42:43], s[74:75]
    buffer_load_dwordx2 v[20:21], v117, s[4:7], 0 offen
    buffer_load_dword v45, v117, s[4:7], 0 offen offset:8
    s_mov_b64 exec, -1
    v_lshrrev_b32 v112, 16, v46
    v_and_b32 v113, 0xffff, v46
    v_add_u32 v114, 17039360, v15
    v_cmp_gt_u32 s[40:41], v112, v16
    v_lshl_add_u32 v114, v113, 2, v114
    s_and_b64 exec, s[40:41], s[74:75]
    buffer_load_dwordx2 v[22:23], v114, s[4:7], 0 offen
    buffer_load_dword v46, v114, s[4:7], 0 offen offset:8
    s_mov_b64 exec, -1
    v_lshrrev_b32 v115, 16, v47
    v_and_b32 v116, 0xffff, v47
    v_add_u32 v117, 25559040, v15
    v_cmp_gt_u32 s[42:43], v115, v16
    v_lshl_add_u32 v117, v116, 2, v117
    s_and_b64 exec, s[42:43], s[74:75]
    buffer_load_dwordx2 v[24:25], v117, s[4:7], 0 offen
    buffer_load_dword v47, v117, s[4:7], 0 offen offset:8
    s_mov_b64 exec, -1
    v_lshrrev_b32 v112, 16, v48
    v_and_b32 v113, 0xffff, v48
    v_add_u32 v114, 34078720, v15
    v_cmp_gt_u32 s[40:41], v112, v16
    v_lshl_add_u32 v114, v113, 2, v114
    s_and_b64 exec, s[40:41], s[74:75]
    buffer_load_dwordx2 v[26:27], v114, s[4:7], 0 offen
    buffer_load_dword v48, v114, s[4:7], 0 offen offset:8
    s_mov_b64 exec, -1
    v_lshrrev_b32 v115, 16, v49
    v_and_b32 v116, 0xffff, v49
    v_add_u32 v117, 42598400, v15
    v_cmp_gt_u32 s[42:43], v115, v16
    v_lshl_add_u32 v117, v116, 2, v117
    s_and_b64 exec, s[42:43], s[74:75]
    buffer_load_dwordx2 v[28:29], v117, s[4:7], 0 offen
    buffer_load_dword v49, v117, s[4:7], 0 offen offset:8
    s_mov_b64 exec, -1
    v_lshrrev_b32 v112, 16, v50
    v_and_b32 v113, 0xffff, v50
    v_add_u32 v114, 51118080, v15
    v_cmp_gt_u32 s[40:41], v112, v16
    v_lshl_add_u32 v114, v113, 2, v114
    s_and_b64 exec, s[40:41], s[74:75]
    buffer_load_dwordx2 v[30:31], v114, s[4:7], 0 offen
    buffer_load_dword v50, v114, s[4:7], 0 offen offset:8
    s_mov_b64 exec, -1
    v_lshrrev_b32 v115, 16, v51
    v_and_b32 v116, 0xffff, v51
    v_add_u32 v117, 59637760, v15
    v_cmp_gt_u32 s[42:43], v115, v16
    v_lshl_add_u32 v117, v116, 2, v117
    s_and_b64 exec, s[42:43], s[74:75]
    buffer_load_dwordx2 v[32:33], v117, s[4:7], 0 offen
    buffer_load_dword v51, v117, s[4:7], 0 offen offset:8
    s_mov_b64 exec, -1
    v_lshrrev_b32 v112, 16, v52
    v_and_b32 v113, 0xffff, v52
    v_add_u32 v114, 68157440, v15
    v_cmp_gt_u32 s[40:41], v112, v16
    v_lshl_add_u32 v114, v113, 2, v114
    s_and_b64 exec, s[40:41], s[74:75]
    buffer_load_dwordx2 v[34:35], v114, s[4:7], 0 offen
    buffer_load_dword v52, v114, s[4:7], 0 offen offset:8
    s_mov_b64 exec, -1
    v_lshrrev_b32 v115, 16, v53
    v_and_b32 v116, 0xffff, v53
    v_add_u32 v117, 76677120, v15
    v_cmp_gt_u32 s[42:43], v115, v16
    v_lshl_add_u32 v117, v116, 2, v117
    s_and_b64 exec, s[42:43], s[74:75]
    buffer_load_dwordx2 v[36:37], v117, s[4:7], 0 offen
    buffer_load_dword v53, v117, s[4:7], 0 offen offset:8
    s_mov_b64 exec, -1
    v_lshrrev_b32 v112, 16, v54
    v_and_b32 v113, 0xffff, v54
    v_add_u32 v114, 85196800, v15
    v_cmp_gt_u32 s[40:41], v112, v16
    v_lshl_add_u32 v114, v113, 2, v114
    s_and_b64 exec, s[40:41], s[74:75]
    buffer_load_dwordx2 v[38:39], v114, s[4:7], 0 offen
    buffer_load_dword v54, v114, s[4:7], 0 offen offset:8
    s_mov_b64 exec, -1
    v_lshrrev_b32 v115, 16, v55
    v_and_b32 v116, 0xffff, v55
    v_add_u32 v117, 93716480, v15
    v_cmp_gt_u32 s[42:43], v115, v16
    v_lshl_add_u32 v117, v116, 2, v117
    s_and_b64 exec, s[42:43], s[74:75]
    buffer_load_dwordx2 v[40:41], v117, s[4:7], 0 offen
    buffer_load_dword v55, v117, s[4:7], 0 offen offset:8
    s_mov_b64 exec, -1
    v_lshrrev_b32 v112, 16, v56
    v_and_b32 v113, 0xffff, v56
    v_add_u32 v114, 102236160, v15
    v_cmp_gt_u32 s[40:41], v112, v16
    v_lshl_add_u32 v114, v113, 2, v114
    s_and_b64 exec, s[40:41], s[74:75]
    buffer_load_dwordx2 v[42:43], v114, s[4:7], 0 offen
    buffer_load_dword v56, v114, s[4:7], 0 offen offset:8
    s_mov_b64 exec, -1
    s_branch P_hist
P_quarter:
    s_cmp_eq_u32 s66, 1
    s_cselect_b32 s67, 0, 1
    s_cselect_b64 s[74:75], 0, -1
    s_lshr_b32 s23, s2, 4
    s_and_b32 s23, s23, 15
    s_mul_i32 s23, s23, 50048
    s_add_u32 s23, s23, s25
    v_lshlrev_b32 v81, 7, v0
    v_add_u32 v81, s23, v81
    v_cmp_gt_u32 vcc, 391, v0
    s_and_saveexec_b64 s[34:35], vcc
    buffer_load_dword v81, v81, s[8:11], 0 offen
    s_mov_b64 exec, s[34:35]
    s_cmp_lg_u32 s16, 0
    s_cbranch_scc1 P_noscan
    s_mov_b32 s23, 0
    s_mov_b32 s28, 0
P_scanpass:
    s_cmp_eq_u32 s28, 0
    s_cselect_b32 s30, 49, 64
    v_cmp_gt_u32 vcc, s30, v1
    v_lshlrev_b32 v5, 6, v1
    s_lshl_b32 s24, s28, 12
    s_add_u32 s24, s24, 156000
    v_add_u32 v5, s24, v5
    v_mov_b32 v110, 0
    v_mov_b32 v111, 0
    v_mov_b32 v112, 0
    v_mov_b32 v113, 0
    v_mov_b32 v114, 0
    v_mov_b32 v115, 0
    v_mov_b32 v116, 0
    v_mov_b32 v117, 0
    v_mov_b32 v118, 0
    v_mov_b32 v119, 0
    v_mov_b32 v120, 0
    v_mov_b32 v121, 0
    v_mov_b32 v122, 0
    v_mov_b32 v123, 0
    v_mov_b32 v124, 0
    v_mov_b32 v125, 0
    s_and_saveexec_b64 s[34:35], vcc
    ds_read_b128 v[110:113], v5 offset:0
    ds_read_b128 v[114:117], v5 offset:16
    ds_read_b128 v[118:121], v5 offset:32
    ds_read_b128 v[122:125], v5 offset:48
    s_mov_b64 exec, s[34:35]
    s_waitcnt lgkmcnt(0)
    v_add_u32 v111, v111, v110
    v_add_u32 v112, v112, v111
    v_add_u32 v113, v113, v112
    v_add_u32 v114, v114, v113
    v_add_u32 v115, v115, v114
    v_add_u32 v116, v116, v115
    v_add_u32 v117, v117, v116
    v_add_u32 v118, v118, v117
    v_add_u32 v119, v119, v118
    v_add_u32 v120, v120, v119
    v_add_u32 v121, v121, v120
    v_add_u32 v122, v122, v121
    v_add_u32 v123, v123, v122
    v_add_u32 v124, v124, v123
    v_add_u32 v125, v125, v124
    v_mov_b32 v126, v125
    s_nop 1
    v_add_u32_dpp v126, v126, v126 row_shr:1 row_mask:0xf bank_mask:0xf
    s_nop 1
    v_add_u32_dpp v126, v126, v126 row_shr:2 row_mask:0xf bank_mask:0xf
    s_nop 1
    v_add_u32_dpp v126, v126, v126 row_shr:4 row_mask:0xf bank_mask:0xf
    s_nop 1
    v_add_u32_dpp v126, v126, v126 row_shr:8 row_mask:0xf bank_mask:0xf
    s_nop 1
    v_add_u32_dpp v126, v126, v126 row_bcast:15 row_mask:0xa bank_mask:0xf
    s_nop 1
    v_add_u32_dpp v126, v126, v126 row_bcast:31 row_mask:0xc bank_mask:0xf
    s_nop 1
    v_readlane_b32 s24, v126, 63
    v_sub_u32 v126, v126, v125
    v_add_u32 v126, s23, v126
    s_add_u32 s23, s23, s24
    v_add_u32 v125, v126, v124
    v_add_u32 v124, v126, v123
    v_add_u32 v123, v126, v122
    v_add_u32 v122, v126, v121
    v_add_u32 v121, v126, v120
    v_add_u32 v120, v126, v119
    v_add_u32 v119, v126, v118
    v_add_u32 v118, v126, v117
    v_add_u32 v117, v126, v116
    v_add_u32 v116, v126, v115
    v_add_u32 v115, v126, v114
    v_add_u32 v114, v126, v113
    v_add_u32 v113, v126, v112
    v_add_u32 v112, v126, v111
    v_add_u32 v111, v126, v110
    v_mov_b32 v110, v126
    s_and_saveexec_b64 s[34:35], vcc
    ds_write_b128 v5, v[110:113] offset:0
    ds_write_b128 v5, v[114:117] offset:16
    ds_write_b128 v5, v[118:121] offset:32
    ds_write_b128 v5, v[122:125] offset:48
    s_mov_b64 exec, s[34:35]
    s_add_u32 s28, s28, 1
    s_cmp_lt_u32 s28, 1
    s_cbranch_scc1 P_scanpass
    v_mov_b32 v110, 159156
    v_mov_b32 v111, s23
    ds_write_b32 v110, v111
    s_waitcnt lgkmcnt(0)
P_noscan:
    s_barrier
    v_cmp_le_i32 s[40:41], 0, v58
    v_lshrrev_b32 v116, 5, v58
    v_and_b32 v116, 0xffc, v116
    v_add_u32 v116, 156000, v116
    s_mov_b64 exec, s[40:41]
    ds_add_rtn_u32 v110, v116, v4
    s_mov_b64 exec, -1
    v_cmp_le_i32 s[42:43], 0, v59
    v_lshrrev_b32 v117, 5, v59
    v_and_b32 v117, 0xffc, v117
    v_add_u32 v117, 156000, v117
    s_mov_b64 exec, s[42:43]
    ds_add_rtn_u32 v111, v117, v4
    s_mov_b64 exec, -1
    v_cmp_le_i32 s[44:45], 0, v60
    v_lshrrev_b32 v116, 5, v60
    v_and_b32 v116, 0xffc, v116
    v_add_u32 v116, 156000, v116
    s_mov_b64 exec, s[44:45]
    ds_add_rtn_u32 v112, v116, v4
    s_mov_b64 exec, -1
    v_cmp_le_i32 s[46:47], 0, v61
    v_lshrrev_b32 v117, 5, v61
    v_and_b32 v117, 0xffc, v117
    v_add_u32 v117, 156000, v117
    s_mov_b64 exec, s[46:47]
    ds_add_rtn_u32 v113, v117, v4
    s_mov_b64 exec, -1
    v_cmp_le_i32 s[48:49], 0, v62
    v_lshrrev_b32 v116, 5, v62
    v_and_b32 v116, 0xffc, v116
    v_add_u32 v116, 156000, v116
    s_mov_b64 exec, s[48:49]
    ds_add_rtn_u32 v114, v116, v4
    s_mov_b64 exec, -1
    v_cmp_le_i32 s[50:51], 0, v63
    v_lshrrev_b32 v117, 5, v63
    v_and_b32 v117, 0xffc, v117
    v_add_u32 v117, 156000, v117
    s_mov_b64 exec, s[50:51]
    ds_add_rtn_u32 v115, v117, v4
    s_mov_b64 exec, -1
    s_waitcnt lgkmcnt(5)
    s_mov_b64 exec, s[40:41]
    v_lshlrev_b32 v118, 2, v110
    v_lshl_add_u32 v119, v110, 1, s33
    ds_write_b32 v118, v58
    ds_write_b16 v119, v57
    s_waitcnt lgkmcnt(6)
    s_mov_b64 exec, s[42:43]
    v_lshlrev_b32 v120, 2, v111
    v_lshl_add_u32 v121, v111, 1, s33
    ds_write_b32 v120, v59
    ds_write_b16_d16_hi v121, v57
    s_waitcnt lgkmcnt(7)
    s_mov_b64 exec, s[44:45]
    v_lshlrev_b32 v118, 2, v112
    v_lshl_add_u32 v119, v112, 1, s33
    ds_write_b32 v118, v60
    ds_write_b16 v119, v74
    s_waitcnt lgkmcnt(8)
    s_mov_b64 exec, s[46:47]
    v_lshlrev_b32 v120, 2, v113
    v_lshl_add_u32 v121, v113, 1, s33
    ds_write_b32 v120, v61
    ds_write_b16_d16_hi v121, v74
    s_waitcnt lgkmcnt(9)
    s_mov_b64 exec, s[48:49]
    v_lshlrev_b32 v118, 2, v114
    v_lshl_add_u32 v119, v114, 1, s33
    ds_write_b32 v118, v62
    ds_write_b16 v119, v75
    s_waitcnt lgkmcnt(10)
    s_mov_b64 exec, s[50:51]
    v_lshlrev_b32 v120, 2, v115
    v_lshl_add_u32 v121, v115, 1, s33
    ds_write_b32 v120, v63
    ds_write_b16_d16_hi v121, v75
    s_mov_b64 exec, -1
    v_cmp_le_i32 s[40:41], 0, v64
    v_lshrrev_b32 v116, 5, v64
    v_and_b32 v116, 0xffc, v116
    v_add_u32 v116, 156000, v116
    s_mov_b64 exec, s[40:41]
    ds_add_rtn_u32 v110, v116, v4
    s_mov_b64 exec, -1
    v_cmp_le_i32 s[42:43], 0, v65
    v_lshrrev_b32 v117, 5, v65
    v_and_b32 v117, 0xffc, v117
    v_add_u32 v117, 156000, v117
    s_mov_b64 exec, s[42:43]
    ds_add_rtn_u32 v111, v117, v4
    s_mov_b64 exec, -1
    v_cmp_le_i32 s[44:45], 0, v66
    v_lshrrev_b32 v116, 5, v66
    v_and_b32 v116, 0xffc, v116
    v_add_u32 v116, 156000, v116
    s_mov_b64 exec, s[44:45]
    ds_add_rtn_u32 v112, v116, v4
    s_mov_b64 exec, -1
    v_cmp_le_i32 s[46:47], 0, v67
    v_lshrrev_b32 v117, 5, v67
    v_and_b32 v117, 0xffc, v117
    v_add_u32 v117, 156000, v117
    s_mov_b64 exec, s[46:47]
    ds_add_rtn_u32 v113, v117, v4
    s_mov_b64 exec, -1
    v_cmp_le_i32 s[48:49], 0, v68
    v_lshrrev_b32 v116, 5, v68
    v_and_b32 v116, 0xffc, v116
    v_add_u32 v116, 156000, v116
    s_mov_b64 exec, s[48:49]
    ds_add_rtn_u32 v114, v116, v4
    s_mov_b64 exec, -1
    v_cmp_le_i32 s[50:51], 0, v69
    v_lshrrev_b32 v117, 5, v69
    v_and_b32 v117, 0xffc, v117
    v_add_u32 v117, 156000, v117
    s_mov_b64 exec, s[50:51]
    ds_add_rtn_u32 v115, v117, v4
    s_mov_b64 exec, -1
    s_waitcnt lgkmcnt(5)
    s_mov_b64 exec, s[40:41]
    v_lshlrev_b32 v118, 2, v110
    v_lshl_add_u32 v119, v110, 1, s33
    ds_write_b32 v118, v64
    ds_write_b16 v119, v76
    s_waitcnt lgkmcnt(6)
    s_mov_b64 exec, s[42:43]
    v_lshlrev_b32 v120, 2, v111
    v_lshl_add_u32 v121, v111, 1, s33
    ds_write_b32 v120, v65
    ds_write_b16_d16_hi v121, v76
    s_waitcnt lgkmcnt(7)
    s_mov_b64 exec, s[44:45]
    v_lshlrev_b32 v118, 2, v112
    v_lshl_add_u32 v119, v112, 1, s33
    ds_write_b32 v118, v66
    ds_write_b16 v119, v77
    s_waitcnt lgkmcnt(8)
    s_mov_b64 exec, s[46:47]
    v_lshlrev_b32 v120, 2, v113
    v_lshl_add_u32 v121, v113, 1, s33
    ds_write_b32 v120, v67
    ds_write_b16_d16_hi v121, v77
    s_waitcnt lgkmcnt(9)
    s_mov_b64 exec, s[48:49]
    v_lshlrev_b32 v118, 2, v114
    v_lshl_add_u32 v119, v114, 1, s33
    ds_write_b32 v118, v68
    ds_write_b16 v119, v78
    s_waitcnt lgkmcnt(10)
    s_mov_b64 exec, s[50:51]
    v_lshlrev_b32 v120, 2, v115
    v_lshl_add_u32 v121, v115, 1, s33
    ds_write_b32 v120, v69
    ds_write_b16_d16_hi v121, v78
    s_mov_b64 exec, -1
    v_cmp_le_i32 s[40:41], 0, v70
    v_lshrrev_b32 v116, 5, v70
    v_and_b32 v116, 0xffc, v116
    v_add_u32 v116, 156000, v116
    s_mov_b64 exec, s[40:41]
    ds_add_rtn_u32 v110, v116, v4
    s_mov_b64 exec, -1
    v_cmp_le_i32 s[42:43], 0, v71
    v_lshrrev_b32 v117, 5, v71
    v_and_b32 v117, 0xffc, v117
    v_add_u32 v117, 156000, v117
    s_mov_b64 exec, s[42:43]
    ds_add_rtn_u32 v111, v117, v4
    s_mov_b64 exec, -1
    v_cmp_le_i32 s[44:45], 0, v72
    v_lshrrev_b32 v116, 5, v72
    v_and_b32 v116, 0xffc, v116
    v_add_u32 v116, 156000, v116
    s_mov_b64 exec, s[44:45]
    ds_add_rtn_u32 v112, v116, v4
    s_mov_b64 exec, -1
    v_cmp_le_i32 s[46:47], 0, v73
    v_lshrrev_b32 v117, 5, v73
    v_and_b32 v117, 0xffc, v117
    v_add_u32 v117, 156000, v117
    s_mov_b64 exec, s[46:47]
    ds_add_rtn_u32 v113, v117, v4
    s_mov_b64 exec, -1
    v_cmp_le_i32 s[48:49], 0, v18
    v_lshrrev_b32 v116, 5, v18
    v_and_b32 v116, 0xffc, v116
    v_add_u32 v116, 156000, v116
    s_mov_b64 exec, s[48:49]
    ds_add_rtn_u32 v114, v116, v4
    s_mov_b64 exec, -1
    v_cmp_le_i32 s[50:51], 0, v19
    v_lshrrev_b32 v117, 5, v19
    v_and_b32 v117, 0xffc, v117
    v_add_u32 v117, 156000, v117
    s_mov_b64 exec, s[50:51]
    ds_add_rtn_u32 v115, v117, v4
    s_mov_b64 exec, -1
    s_waitcnt lgkmcnt(5)
    s_mov_b64 exec, s[40:41]
    v_lshlrev_b32 v118, 2, v110
    v_lshl_add_u32 v119, v110, 1, s33
    ds_write_b32 v118, v70
    ds_write_b16 v119, v79
    s_waitcnt lgkmcnt(6)
    s_mov_b64 exec, s[42:43]
    v_lshlrev_b32 v120, 2, v111
    v_lshl_add_u32 v121, v111, 1, s33
    ds_write_b32 v120, v71
    ds_write_b16_d16_hi v121, v79
    s_waitcnt lgkmcnt(7)
    s_mov_b64 exec, s[44:45]
    v_lshlrev_b32 v118, 2, v112
    v_lshl_add_u32 v119, v112, 1, s33
    ds_write_b32 v118, v72
    ds_write_b16 v119, v80
    s_waitcnt lgkmcnt(8)
    s_mov_b64 exec, s[46:47]
    v_lshlrev_b32 v120, 2, v113
    v_lshl_add_u32 v121, v113, 1, s33
    ds_write_b32 v120, v73
    ds_write_b16_d16_hi v121, v80
    s_waitcnt lgkmcnt(9)
    s_mov_b64 exec, s[48:49]
    v_lshlrev_b32 v118, 2, v114
    v_lshl_add_u32 v119, v114, 1, s33
    ds_write_b32 v118, v18
    ds_write_b16 v119, v44
    s_waitcnt lgkmcnt(10)
    s_mov_b64 exec, s[50:51]
    v_lshlrev_b32 v120, 2, v115
    v_lshl_add_u32 v121, v115, 1, s33
    ds_write_b32 v120, v19
    ds_write_b16_d16_hi v121, v44
    s_mov_b64 exec, -1
    s_cmp_eq_u32 s67, 0
    s_cbranch_scc1 P_nopf
    v_add_u32 v127, 208, v17
    ds_bpermute_b32 v57, v127, v7
    v_mov_b32 v58, -1
    v_mov_b32 v59, -1
    v_add_u32 v126, 224, v17
    ds_bpermute_b32 v74, v126, v7
    v_mov_b32 v60, -1
    v_mov_b32 v61, -1
    v_add_u32 v127, 240, v17
    ds_bpermute_b32 v75, v127, v7
    v_mov_b32 v62, -1
    v_mov_b32 v63, -1
    v_add_u32 v126, 0, v17
    ds_bpermute_b32 v76, v126, v11
    v_mov_b32 v64, -1
    v_mov_b32 v65, -1
    v_add_u32 v127, 16, v17
    ds_bpermute_b32 v77, v127, v11
    v_mov_b32 v66, -1
    v_mov_b32 v67, -1
    v_add_u32 v126, 32, v17
    ds_bpermute_b32 v78, v126, v11
    v_mov_b32 v68, -1
    v_mov_b32 v69, -1
    v_add_u32 v127, 48, v17
    ds_bpermute_b32 v79, v127, v11
    v_mov_b32 v70, -1
    v_mov_b32 v71, -1
    s_waitcnt lgkmcnt(0)
    v_lshrrev_b32 v115, 16, v57
    v_and_b32 v116, 0xffff, v57
    v_add_u32 v117, 110755840, v15
    v_cmp_gt_u32 s[42:43], v115, v16
    v_lshl_add_u32 v117, v116, 2, v117
    s_and_b64 exec, s[42:43], s[74:75]
    buffer_load_dwordx2 v[58:59], v117, s[4:7], 0 offen
    buffer_load_dword v57, v117, s[4:7], 0 offen offset:8
    s_mov_b64 exec, -1
    v_lshrrev_b32 v112, 16, v74
    v_and_b32 v113, 0xffff, v74
    v_add_u32 v114, 119275520, v15
    v_cmp_gt_u32 s[40:41], v112, v16
    v_lshl_add_u32 v114, v113, 2, v114
    s_and_b64 exec, s[40:41], s[74:75]
    buffer_load_dwordx2 v[60:61], v114, s[4:7], 0 offen
    buffer_load_dword v74, v114, s[4:7], 0 offen offset:8
    s_mov_b64 exec, -1
    v_lshrrev_b32 v115, 16, v75
    v_and_b32 v116, 0xffff, v75
    v_add_u32 v117, 127795200, v15
    v_cmp_gt_u32 s[42:43], v115, v16
    v_lshl_add_u32 v117, v116, 2, v117
    s_and_b64 exec, s[42:43], s[74:75]
    buffer_load_dwordx2 v[62:63], v117, s[4:7], 0 offen
    buffer_load_dword v75, v117, s[4:7], 0 offen offset:8
    s_mov_b64 exec, -1
    v_lshrrev_b32 v112, 16, v76
    v_and_b32 v113, 0xffff, v76
    v_add_u32 v114, 136314880, v15
    v_cmp_gt_u32 s[40:41], v112, v16
    v_lshl_add_u32 v114, v113, 2, v114
    s_and_b64 exec, s[40:41], s[74:75]
    buffer_load_dwordx2 v[64:65], v114, s[4:7], 0 offen
    buffer_load_dword v76, v114, s[4:7], 0 offen offset:8
    s_mov_b64 exec, -1
    v_lshrrev_b32 v115, 16, v77
    v_and_b32 v116, 0xffff, v77
    v_add_u32 v117, 144834560, v15
    v_cmp_gt_u32 s[42:43], v115, v16
    v_lshl_add_u32 v117, v116, 2, v117
    s_and_b64 exec, s[42:43], s[74:75]
    buffer_load_dwordx2 v[66:67], v117, s[4:7], 0 offen
    buffer_load_dword v77, v117, s[4:7], 0 offen offset:8
    s_mov_b64 exec, -1
    v_lshrrev_b32 v112, 16, v78
    v_and_b32 v113, 0xffff, v78
    v_add_u32 v114, 153354240, v15
    v_cmp_gt_u32 s[40:41], v112, v16
    v_lshl_add_u32 v114, v113, 2, v114
    s_and_b64 exec, s[40:41], s[74:75]
    buffer_load_dwordx2 v[68:69], v114, s[4:7], 0 offen
    buffer_load_dword v78, v114, s[4:7], 0 offen offset:8
    s_mov_b64 exec, -1
    v_lshrrev_b32 v115, 16, v79
    v_and_b32 v116, 0xffff, v79
    v_add_u32 v117, 161873920, v15
    v_cmp_gt_u32 s[42:43], v115, v16
    v_lshl_add_u32 v117, v116, 2, v117
    s_and_b64 exec, s[42:43], s[74:75]
    buffer_load_dwordx2 v[70:71], v117, s[4:7], 0 offen
    buffer_load_dword v79, v117, s[4:7], 0 offen offset:8
    s_mov_b64 exec, -1
    v_mov_b32 v72, -1
    v_mov_b32 v73, -1
    v_mov_b32 v110, 0
    v_mov_b32 v111, 0
    s_mov_b32 s28, 0
    v_lshrrev_b32 v112, 16, v7
    v_cmp_lt_u32 s[64:65], 32, v112
P_ov2_0:
    s_cmp_eq_u64 s[64:65], 0
    s_cbranch_scc1 P_ov2_0_done
    s_cmp_ge_u32 s28, 4
    s_cbranch_scc1 P_ov2_0_done
    s_ff1_i32_b64 s23, s[64:65]
    s_bitset0_b64 s[64:65], s23
    v_readlane_b32 s32, v7, s23
    s_add_u32 s23, s23, 0
    s_mul_i32 s23, s23, 2129920
    s_add_u32 s23, s23, s26
    s_and_b32 s24, s32, 0xffff
    s_lshl_b32 s24, s24, 2
    s_add_u32 s23, s23, s24
    s_add_u32 s23, s23, 192
    s_lshr_b32 s32, s32, 16
    s_sub_u32 s32, s32, 32
    s_lshl_b32 s24, s28, 4
    s_lshl_b64 exec, 0xffff, s24
    v_mov_b32 v110, s32
    v_add_u32 v111, s23, v14
    s_mov_b64 exec, -1
    s_add_u32 s28, s28, 1
    s_branch P_ov2_0
P_ov2_0_done:
    v_lshrrev_b32 v112, 16, v11
    v_cmp_lt_u32 s[64:65], 32, v112
P_ov2_1:
    s_cmp_eq_u64 s[64:65], 0
    s_cbranch_scc1 P_ov2_1_done
    s_cmp_ge_u32 s28, 4
    s_cbranch_scc1 P_ov2_1_done
    s_ff1_i32_b64 s23, s[64:65]
    s_bitset0_b64 s[64:65], s23
    v_readlane_b32 s32, v11, s23
    s_add_u32 s23, s23, 64
    s_mul_i32 s23, s23, 2129920
    s_add_u32 s23, s23, s26
    s_and_b32 s24, s32, 0xffff
    s_lshl_b32 s24, s24, 2
    s_add_u32 s23, s23, s24
    s_add_u32 s23, s23, 192
    s_lshr_b32 s32, s32, 16
    s_sub_u32 s32, s32, 32
    s_lshl_b32 s24, s28, 4
    s_lshl_b64 exec, 0xffff, s24
    v_mov_b32 v110, s32
    v_add_u32 v111, s23, v14
    s_mov_b64 exec, -1
    s_add_u32 s28, s28, 1
    s_branch P_ov2_1
P_ov2_1_done:
    v_cmp_gt_u32 s[44:45], v110, v16
    s_and_b64 exec, s[44:45], s[74:75]
    buffer_load_dwordx2 v[72:73], v111, s[4:7], 0 offen
    buffer_load_dword v80, v111, s[4:7], 0 offen offset:8
    s_mov_b64 exec, -1
P_nopf:
    v_cmp_le_i32 s[40:41], 0, v20
    v_lshrrev_b32 v116, 5, v20
    v_and_b32 v116, 0xffc, v116
    v_add_u32 v116, 156000, v116
    s_mov_b64 exec, s[40:41]
    ds_add_rtn_u32 v110, v116, v4
    s_mov_b64 exec, -1
    v_cmp_le_i32 s[42:43], 0, v21
    v_lshrrev_b32 v117, 5, v21
    v_and_b32 v117, 0xffc, v117
    v_add_u32 v117, 156000, v117
    s_mov_b64 exec, s[42:43]
    ds_add_rtn_u32 v111, v117, v4
    s_mov_b64 exec, -1
    v_cmp_le_i32 s[44:45], 0, v22
    v_lshrrev_b32 v116, 5, v22
    v_and_b32 v116, 0xffc, v116
    v_add_u32 v116, 156000, v116
    s_mov_b64 exec, s[44:45]
    ds_add_rtn_u32 v112, v116, v4
    s_mov_b64 exec, -1
    v_cmp_le_i32 s[46:47], 0, v23
    v_lshrrev_b32 v117, 5, v23
    v_and_b32 v117, 0xffc, v117
    v_add_u32 v117, 156000, v117
    s_mov_b64 exec, s[46:47]
    ds_add_rtn_u32 v113, v117, v4
    s_mov_b64 exec, -1
    v_cmp_le_i32 s[48:49], 0, v24
    v_lshrrev_b32 v116, 5, v24
    v_and_b32 v116, 0xffc, v116
    v_add_u32 v116, 156000, v116
    s_mov_b64 exec, s[48:49]
    ds_add_rtn_u32 v114, v116, v4
    s_mov_b64 exec, -1
    v_cmp_le_i32 s[50:51], 0, v25
    v_lshrrev_b32 v117, 5, v25
    v_and_b32 v117, 0xffc, v117
    v_add_u32 v117, 156000, v117
    s_mov_b64 exec, s[50:51]
    ds_add_rtn_u32 v115, v117, v4
    s_mov_b64 exec, -1
    s_waitcnt lgkmcnt(5)
    s_mov_b64 exec, s[40:41]
    v_lshlrev_b32 v118, 2, v110
    v_lshl_add_u32 v119, v110, 1, s33
    ds_write_b32 v118, v20
    ds_write_b16 v119, v45
    s_waitcnt lgkmcnt(6)
    s_mov_b64 exec, s[42:43]
    v_lshlrev_b32 v120, 2, v111
    v_lshl_add_u32 v121, v111, 1, s33
    ds_write_b32 v120, v21
    ds_write_b16_d16_hi v121, v45
    s_waitcnt lgkmcnt(7)
    s_mov_b64 exec, s[44:45]
    v_lshlrev_b32 v118, 2, v112
    v_lshl_add_u32 v119, v112, 1, s33
    ds_write_b32 v118, v22
    ds_write_b16 v119, v46
    s_waitcnt lgkmcnt(8)
    s_mov_b64 exec, s[46:47]
    v_lshlrev_b32 v120, 2, v113
    v_lshl_add_u32 v121, v113, 1, s33
    ds_write_b32 v120, v23
    ds_write_b16_d16_hi v121, v46
    s_waitcnt lgkmcnt(9)
    s_mov_b64 exec, s[48:49]
    v_lshlrev_b32 v118, 2, v114
    v_lshl_add_u32 v119, v114, 1, s33
    ds_write_b32 v118, v24
    ds_write_b16 v119, v47
    s_waitcnt lgkmcnt(10)
    s_mov_b64 exec, s[50:51]
    v_lshlrev_b32 v120, 2, v115
    v_lshl_add_u32 v121, v115, 1, s33
    ds_write_b32 v120, v25
    ds_write_b16_d16_hi v121, v47
    s_mov_b64 exec, -1
    v_cmp_le_i32 s[40:41], 0, v26
    v_lshrrev_b32 v116, 5, v26
    v_and_b32 v116, 0xffc, v116
    v_add_u32 v116, 156000, v116
    s_mov_b64 exec, s[40:41]
    ds_add_rtn_u32 v110, v116, v4
    s_mov_b64 exec, -1
    v_cmp_le_i32 s[42:43], 0, v27
    v_lshrrev_b32 v117, 5, v27
    v_and_b32 v117, 0xffc, v117
    v_add_u32 v117, 156000, v117
    s_mov_b64 exec, s[42:43]
    ds_add_rtn_u32 v111, v117, v4
    s_mov_b64 exec, -1
    v_cmp_le_i32 s[44:45], 0, v28
    v_lshrrev_b32 v116, 5, v28
    v_and_b32 v116, 0xffc, v116
    v_add_u32 v116, 156000, v116
    s_mov_b64 exec, s[44:45]
    ds_add_rtn_u32 v112, v116, v4
    s_mov_b64 exec, -1
    v_cmp_le_i32 s[46:47], 0, v29
    v_lshrrev_b32 v117, 5, v29
    v_and_b32 v117, 0xffc, v117
    v_add_u32 v117, 156000, v117
    s_mov_b64 exec, s[46:47]
    ds_add_rtn_u32 v113, v117, v4
    s_mov_b64 exec, -1
    v_cmp_le_i32 s[48:49], 0, v30
    v_lshrrev_b32 v116, 5, v30
    v_and_b32 v116, 0xffc, v116
    v_add_u32 v116, 156000, v116
    s_mov_b64 exec, s[48:49]
    ds_add_rtn_u32 v114, v116, v4
    s_mov_b64 exec, -1
    v_cmp_le_i32 s[50:51], 0, v31
    v_lshrrev_b32 v117, 5, v31
    v_and_b32 v117, 0xffc, v117
    v_add_u32 v117, 156000, v117
    s_mov_b64 exec, s[50:51]
    ds_add_rtn_u32 v115, v117, v4
    s_mov_b64 exec, -1
    s_waitcnt lgkmcnt(5)
    s_mov_b64 exec, s[40:41]
    v_lshlrev_b32 v118, 2, v110
    v_lshl_add_u32 v119, v110, 1, s33
    ds_write_b32 v118, v26
    ds_write_b16 v119, v48
    s_waitcnt lgkmcnt(6)
    s_mov_b64 exec, s[42:43]
    v_lshlrev_b32 v120, 2, v111
    v_lshl_add_u32 v121, v111, 1, s33
    ds_write_b32 v120, v27
    ds_write_b16_d16_hi v121, v48
    s_waitcnt lgkmcnt(7)
    s_mov_b64 exec, s[44:45]
    v_lshlrev_b32 v118, 2, v112
    v_lshl_add_u32 v119, v112, 1, s33
    ds_write_b32 v118, v28
    ds_write_b16 v119, v49
    s_waitcnt lgkmcnt(8)
    s_mov_b64 exec, s[46:47]
    v_lshlrev_b32 v120, 2, v113
    v_lshl_add_u32 v121, v113, 1, s33
    ds_write_b32 v120, v29
    ds_write_b16_d16_hi v121, v49
    s_waitcnt lgkmcnt(9)
    s_mov_b64 exec, s[48:49]
    v_lshlrev_b32 v118, 2, v114
    v_lshl_add_u32 v119, v114, 1, s33
    ds_write_b32 v118, v30
    ds_write_b16 v119, v50
    s_waitcnt lgkmcnt(10)
    s_mov_b64 exec, s[50:51]
    v_lshlrev_b32 v120, 2, v115
    v_lshl_add_u32 v121, v115, 1, s33
    ds_write_b32 v120, v31
    ds_write_b16_d16_hi v121, v50
    s_mov_b64 exec, -1
    v_cmp_le_i32 s[40:41], 0, v32
    v_lshrrev_b32 v116, 5, v32
    v_and_b32 v116, 0xffc, v116
    v_add_u32 v116, 156000, v116
    s_mov_b64 exec, s[40:41]
    ds_add_rtn_u32 v110, v116, v4
    s_mov_b64 exec, -1
    v_cmp_le_i32 s[42:43], 0, v33
    v_lshrrev_b32 v117, 5, v33
    v_and_b32 v117, 0xffc, v117
    v_add_u32 v117, 156000, v117
    s_mov_b64 exec, s[42:43]
    ds_add_rtn_u32 v111, v117, v4
    s_mov_b64 exec, -1
    v_cmp_le_i32 s[44:45], 0, v34
    v_lshrrev_b32 v116, 5, v34
    v_and_b32 v116, 0xffc, v116
    v_add_u32 v116, 156000, v116
    s_mov_b64 exec, s[44:45]
    ds_add_rtn_u32 v112, v116, v4
    s_mov_b64 exec, -1
    v_cmp_le_i32 s[46:47], 0, v35
    v_lshrrev_b32 v117, 5, v35
    v_and_b32 v117, 0xffc, v117
    v_add_u32 v117, 156000, v117
    s_mov_b64 exec, s[46:47]
    ds_add_rtn_u32 v113, v117, v4
    s_mov_b64 exec, -1
    v_cmp_le_i32 s[48:49], 0, v36
    v_lshrrev_b32 v116, 5, v36
    v_and_b32 v116, 0xffc, v116
    v_add_u32 v116, 156000, v116
    s_mov_b64 exec, s[48:49]
    ds_add_rtn_u32 v114, v116, v4
    s_mov_b64 exec, -1
    v_cmp_le_i32 s[50:51], 0, v37
    v_lshrrev_b32 v117, 5, v37
    v_and_b32 v117, 0xffc, v117
    v_add_u32 v117, 156000, v117
    s_mov_b64 exec, s[50:51]
    ds_add_rtn_u32 v115, v117, v4
    s_mov_b64 exec, -1
    s_waitcnt lgkmcnt(5)
    s_mov_b64 exec, s[40:41]
    v_lshlrev_b32 v118, 2, v110
    v_lshl_add_u32 v119, v110, 1, s33
    ds_write_b32 v118, v32
    ds_write_b16 v119, v51
    s_waitcnt lgkmcnt(6)
    s_mov_b64 exec, s[42:43]
    v_lshlrev_b32 v120, 2, v111
    v_lshl_add_u32 v121, v111, 1, s33
    ds_write_b32 v120, v33
    ds_write_b16_d16_hi v121, v51
    s_waitcnt lgkmcnt(7)
    s_mov_b64 exec, s[44:45]
    v_lshlrev_b32 v118, 2, v112
    v_lshl_add_u32 v119, v112, 1, s33
    ds_write_b32 v118, v34
    ds_write_b16 v119, v52
    s_waitcnt lgkmcnt(8)
    s_mov_b64 exec, s[46:47]
    v_lshlrev_b32 v120, 2, v113
    v_lshl_add_u32 v121, v113, 1, s33
    ds_write_b32 v120, v35
    ds_write_b16_d16_hi v121, v52
    s_waitcnt lgkmcnt(9)
    s_mov_b64 exec, s[48:49]
    v_lshlrev_b32 v118, 2, v114
    v_lshl_add_u32 v119, v114, 1, s33
    ds_write_b32 v118, v36
    ds_write_b16 v119, v53
    s_waitcnt lgkmcnt(10)
    s_mov_b64 exec, s[50:51]
    v_lshlrev_b32 v120, 2, v115
    v_lshl_add_u32 v121, v115, 1, s33
    ds_write_b32 v120, v37
    ds_write_b16_d16_hi v121, v53
    s_mov_b64 exec, -1
    v_cmp_le_i32 s[40:41], 0, v38
    v_lshrrev_b32 v116, 5, v38
    v_and_b32 v116, 0xffc, v116
    v_add_u32 v116, 156000, v116
    s_mov_b64 exec, s[40:41]
    ds_add_rtn_u32 v110, v116, v4
    s_mov_b64 exec, -1
    v_cmp_le_i32 s[42:43], 0, v39
    v_lshrrev_b32 v117, 5, v39
    v_and_b32 v117, 0xffc, v117
    v_add_u32 v117, 156000, v117
    s_mov_b64 exec, s[42:43]
    ds_add_rtn_u32 v111, v117, v4
    s_mov_b64 exec, -1
    v_cmp_le_i32 s[44:45], 0, v40
    v_lshrrev_b32 v116, 5, v40
    v_and_b32 v116, 0xffc, v116
    v_add_u32 v116, 156000, v116
    s_mov_b64 exec, s[44:45]
    ds_add_rtn_u32 v112, v116, v4
    s_mov_b64 exec, -1
    v_cmp_le_i32 s[46:47], 0, v41
    v_lshrrev_b32 v117, 5, v41
    v_and_b32 v117, 0xffc, v117
    v_add_u32 v117, 156000, v117
    s_mov_b64 exec, s[46:47]
    ds_add_rtn_u32 v113, v117, v4
    s_mov_b64 exec, -1
    v_cmp_le_i32 s[48:49], 0, v42
    v_lshrrev_b32 v116, 5, v42
    v_and_b32 v116, 0xffc, v116
    v_add_u32 v116, 156000, v116
    s_mov_b64 exec, s[48:49]
    ds_add_rtn_u32 v114, v116, v4
    s_mov_b64 exec, -1
    v_cmp_le_i32 s[50:51], 0, v43
    v_lshrrev_b32 v117, 5, v43
    v_and_b32 v117, 0xffc, v117
    v_add_u32 v117, 156000, v117
    s_mov_b64 exec, s[50:51]
    ds_add_rtn_u32 v115, v117, v4
    s_mov_b64 exec, -1
    s_waitcnt lgkmcnt(5)
    s_mov_b64 exec, s[40:41]
    v_lshlrev_b32 v118, 2, v110
    v_lshl_add_u32 v119, v110, 1, s33
    ds_write_b32 v118, v38
    ds_write_b16 v119, v54
    s_waitcnt lgkmcnt(6)
    s_mov_b64 exec, s[42:43]
    v_lshlrev_b32 v120, 2, v111
    v_lshl_add_u32 v121, v111, 1, s33
    ds_write_b32 v120, v39
    ds_write_b16_d16_hi v121, v54
    s_waitcnt lgkmcnt(7)
    s_mov_b64 exec, s[44:45]
    v_lshlrev_b32 v118, 2, v112
    v_lshl_add_u32 v119, v112, 1, s33
    ds_write_b32 v118, v40
    ds_write_b16 v119, v55
    s_waitcnt lgkmcnt(8)
    s_mov_b64 exec, s[46:47]
    v_lshlrev_b32 v120, 2, v113
    v_lshl_add_u32 v121, v113, 1, s33
    ds_write_b32 v120, v41
    ds_write_b16_d16_hi v121, v55
    s_waitcnt lgkmcnt(9)
    s_mov_b64 exec, s[48:49]
    v_lshlrev_b32 v118, 2, v114
    v_lshl_add_u32 v119, v114, 1, s33
    ds_write_b32 v118, v42
    ds_write_b16 v119, v56
    s_waitcnt lgkmcnt(10)
    s_mov_b64 exec, s[50:51]
    v_lshlrev_b32 v120, 2, v115
    v_lshl_add_u32 v121, v115, 1, s33
    ds_write_b32 v120, v43
    ds_write_b16_d16_hi v121, v56
    s_mov_b64 exec, -1
    s_waitcnt lgkmcnt(0)
    s_barrier
    v_mov_b32 v116, 159156
    ds_read_b32 v116, v116
    v_lshlrev_b32 v110, 3, v0
    v_lshlrev_b32 v111, 2, v0
    v_add_u32 v111, 104000, v111
    v_add_u32 v112, 65536, v110
    ds_read_b64 v[18:19], v110 offset:0
    ds_read_b32 v44, v111 offset:0
    ds_read_b64 v[20:21], v110 offset:8192
    ds_read_b32 v45, v111 offset:4096
    ds_read_b64 v[22:23], v110 offset:16384
    ds_read_b32 v46, v111 offset:8192
    ds_read_b64 v[24:25], v110 offset:24576
    ds_read_b32 v47, v111 offset:12288
    ds_read_b64 v[26:27], v110 offset:32768
    ds_read_b32 v48, v111 offset:16384
    s_waitcnt lgkmcnt(4)
    ds_read_b64 v[28:29], v110 offset:40960
    ds_read_b32 v49, v111 offset:20480
    ds_read_b64 v[30:31], v110 offset:49152
    ds_read_b32 v50, v111 offset:24576
    ds_read_b64 v[32:33], v110 offset:57344
    ds_read_b32 v51, v111 offset:28672
    ds_read_b64 v[34:35], v112 offset:0
    ds_read_b32 v52, v111 offset:32768
    ds_read_b64 v[36:37], v112 offset:8192
    ds_read_b32 v53, v111 offset:36864
    s_waitcnt lgkmcnt(4)
    ds_read_b64 v[38:39], v112 offset:16384
    ds_read_b32 v54, v111 offset:40960
    ds_read_b64 v[40:41], v112 offset:24576
    ds_read_b32 v55, v111 offset:45056
    ds_read_b64 v[42:43], v112 offset:32768
    ds_read_b32 v56, v111 offset:49152
    v_lshlrev_b32 v113, 3, v0
    v_add_u32 v113, 156000, v113
    v_mov_b32 v114, 0
    v_mov_b32 v115, 0
    v_cmp_gt_u32 vcc, 392, v0
    s_and_saveexec_b64 s[34:35], vcc
    ds_write_b64 v113, v[114:115]
    s_mov_b64 exec, s[34:35]
    s_waitcnt lgkmcnt(0)
    v_readfirstlane_b32 s22, v116
    s_barrier
    v_lshlrev_b32 v110, 4, v0
    ds_write_b128 v110, v[82:85] offset:0
    ds_write_b128 v110, v[86:89] offset:16384
    ds_write_b128 v110, v[90:93] offset:32768
    ds_write_b128 v110, v[94:97] offset:49152
    v_add_u32 v110, 65536, v110
    ds_write_b128 v110, v[98:101] offset:0
    ds_write_b128 v110, v[102:105] offset:16384
    v_cmp_gt_u32 vcc, 128, v0
    s_and_saveexec_b64 s[34:35], vcc
    ds_write_b128 v110, v[106:109] offset:32768
    s_mov_b64 exec, s[34:35]
    s_waitcnt lgkmcnt(0)
    s_barrier
    v_lshlrev_b32 v127, 1, v0
    v_add_u32 v126, 0, v127
    v_cmp_gt_u32 s[40:41], s22, v126
    s_mov_b64 exec, s[40:41]
    v_lshlrev_b32 v124, 15, v18
    v_lshrrev_b32 v124, 12, v124
    buffer_load_dwordx2 v[82:83], v124, s[8:11], s25 offen
    s_mov_b64 exec, -1
    v_add_u32 v126, 1, v127
    v_cmp_gt_u32 s[42:43], s22, v126
    s_mov_b64 exec, s[42:43]
    v_lshlrev_b32 v125, 15, v19
    v_lshrrev_b32 v125, 12, v125
    buffer_load_dwordx2 v[84:85], v125, s[8:11], s25 offen
    s_mov_b64 exec, -1
    v_add_u32 v126, 2048, v127
    v_cmp_gt_u32 s[44:45], s22, v126
    s_mov_b64 exec, s[44:45]
    v_lshlrev_b32 v124, 15, v20
    v_lshrrev_b32 v124, 12, v124
    buffer_load_dwordx2 v[86:87], v124, s[8:11], s25 offen
    s_mov_b64 exec, -1
    v_add_u32 v126, 2049, v127
    v_cmp_gt_u32 s[46:47], s22, v126
    s_mov_b64 exec, s[46:47]
    v_lshlrev_b32 v125, 15, v21
    v_lshrrev_b32 v125, 12, v125
    buffer_load_dwordx2 v[88:89], v125, s[8:11], s25 offen
    s_mov_b64 exec, -1
    v_add_u32 v126, 4096, v127
    v_cmp_gt_u32 s[48:49], s22, v126
    s_mov_b64 exec, s[48:49]
    v_lshlrev_b32 v124, 15, v22
    v_lshrrev_b32 v124, 12, v124
    buffer_load_dwordx2 v[90:91], v124, s[8:11], s25 offen
    s_mov_b64 exec, -1
    v_add_u32 v126, 4097, v127
    v_cmp_gt_u32 s[50:51], s22, v126
    s_mov_b64 exec, s[50:51]
    v_lshlrev_b32 v125, 15, v23
    v_lshrrev_b32 v125, 12, v125
    buffer_load_dwordx2 v[92:93], v125, s[8:11], s25 offen
    s_mov_b64 exec, -1
    v_add_u32 v126, 6144, v127
    v_cmp_gt_u32 s[52:53], s22, v126
    s_mov_b64 exec, s[52:53]
    v_lshlrev_b32 v124, 15, v24
    v_lshrrev_b32 v124, 12, v124
    buffer_load_dwordx2 v[94:95], v124, s[8:11], s25 offen
    s_mov_b64 exec, -1
    v_add_u32 v126, 6145, v127
    v_cmp_gt_u32 s[54:55], s22, v126
    s_mov_b64 exec, s[54:55]
    v_lshlrev_b32 v125, 15, v25
    v_lshrrev_b32 v125, 12, v125
    buffer_load_dwordx2 v[96:97], v125, s[8:11], s25 offen
    s_mov_b64 exec, -1
    v_lshlrev_b32 v122, 16, v44
    v_mul_f32 v122, v2, v122
    s_waitcnt vmcnt(7)
    s_mov_b64 exec, s[40:41]
    v_lshlrev_b32 v110, 16, v82
    v_and_b32 v111, v3, v82
    v_lshlrev_b32 v112, 16, v83
    v_and_b32 v113, v3, v83
    v_mul_f32 v110, v122, v110
    v_mul_f32 v111, v122, v111
    v_mul_f32 v112, v122, v112
    v_mul_f32 v113, v122, v113
    v_lshrrev_b32 v82, 14, v18
    v_cvt_rpi_i32_f32 v114, v110
    v_cvt_rpi_i32_f32 v116, v113
    v_cvt_rpi_i32_f32 v111, v111
    v_cvt_rpi_i32_f32 v112, v112
    v_and_b32 v82, 0xfff8, v82
    v_ashrrev_i32 v115, 31, v114
    v_ashrrev_i32 v117, 31, v116
    v_add_u32 v115, v115, v111
    v_add_u32 v117, 0x400000, v117
    v_mad_i64_i32 v[116:117], vcc, v112, s69, v[116:117]
    ds_add_u64 v82, v[114:115]
    ds_add_u64 v82, v[116:117] offset:50176
    s_mov_b64 exec, -1
    v_and_b32 v122, v3, v44
    v_mul_f32 v122, v2, v122
    s_waitcnt vmcnt(6)
    s_mov_b64 exec, s[42:43]
    v_lshlrev_b32 v102, 16, v84
    v_and_b32 v103, v3, v84
    v_lshlrev_b32 v104, 16, v85
    v_and_b32 v105, v3, v85
    v_mul_f32 v102, v122, v102
    v_mul_f32 v103, v122, v103
    v_mul_f32 v104, v122, v104
    v_mul_f32 v105, v122, v105
    v_lshrrev_b32 v84, 14, v19
    v_cvt_rpi_i32_f32 v106, v102
    v_cvt_rpi_i32_f32 v108, v105
    v_cvt_rpi_i32_f32 v103, v103
    v_cvt_rpi_i32_f32 v104, v104
    v_and_b32 v84, 0xfff8, v84
    v_ashrrev_i32 v107, 31, v106
    v_ashrrev_i32 v109, 31, v108
    v_add_u32 v107, v107, v103
    v_add_u32 v109, 0x400000, v109
    v_mad_i64_i32 v[108:109], vcc, v104, s69, v[108:109]
    ds_add_u64 v84, v[106:107]
    ds_add_u64 v84, v[108:109] offset:50176
    s_mov_b64 exec, -1
    v_lshlrev_b32 v122, 16, v45
    v_mul_f32 v122, v2, v122
    s_waitcnt vmcnt(5)
    s_mov_b64 exec, s[44:45]
    v_lshlrev_b32 v110, 16, v86
    v_and_b32 v111, v3, v86
    v_lshlrev_b32 v112, 16, v87
    v_and_b32 v113, v3, v87
    v_mul_f32 v110, v122, v110
    v_mul_f32 v111, v122, v111
    v_mul_f32 v112, v122, v112
    v_mul_f32 v113, v122, v113
    v_lshrrev_b32 v86, 14, v20
    v_cvt_rpi_i32_f32 v114, v110
    v_cvt_rpi_i32_f32 v116, v113
    v_cvt_rpi_i32_f32 v111, v111
    v_cvt_rpi_i32_f32 v112, v112
    v_and_b32 v86, 0xfff8, v86
    v_ashrrev_i32 v115, 31, v114
    v_ashrrev_i32 v117, 31, v116
    v_add_u32 v115, v115, v111
    v_add_u32 v117, 0x400000, v117
    v_mad_i64_i32 v[116:117], vcc, v112, s69, v[116:117]
    ds_add_u64 v86, v[114:115]
    ds_add_u64 v86, v[116:117] offset:50176
    s_mov_b64 exec, -1
    v_and_b32 v122, v3, v45
    v_mul_f32 v122, v2, v122
    s_waitcnt vmcnt(4)
    s_mov_b64 exec, s[46:47]
    v_lshlrev_b32 v102, 16, v88
    v_and_b32 v103, v3, v88
    v_lshlrev_b32 v104, 16, v89
    v_and_b32 v105, v3, v89
    v_mul_f32 v102, v122, v102
    v_mul_f32 v103, v122, v103
    v_mul_f32 v104, v122, v104
    v_mul_f32 v105, v122, v105
    v_lshrrev_b32 v88, 14, v21
    v_cvt_rpi_i32_f32 v106, v102
    v_cvt_rpi_i32_f32 v108, v105
    v_cvt_rpi_i32_f32 v103, v103
    v_cvt_rpi_i32_f32 v104, v104
    v_and_b32 v88, 0xfff8, v88
    v_ashrrev_i32 v107, 31, v106
    v_ashrrev_i32 v109, 31, v108
    v_add_u32 v107, v107, v103
    v_add_u32 v109, 0x400000, v109
    v_mad_i64_i32 v[108:109], vcc, v104, s69, v[108:109]
    ds_add_u64 v88, v[106:107]
    ds_add_u64 v88, v[108:109] offset:50176
    s_mov_b64 exec, -1
    v_lshlrev_b32 v122, 16, v46
    v_mul_f32 v122, v2, v122
    s_waitcnt vmcnt(3)
    s_mov_b64 exec, s[48:49]
    v_lshlrev_b32 v110, 16, v90
    v_and_b32 v111, v3, v90
    v_lshlrev_b32 v112, 16, v91
    v_and_b32 v113, v3, v91
    v_mul_f32 v110, v122, v110
    v_mul_f32 v111, v122, v111
    v_mul_f32 v112, v122, v112
    v_mul_f32 v113, v122, v113
    v_lshrrev_b32 v90, 14, v22
    v_cvt_rpi_i32_f32 v114, v110
    v_cvt_rpi_i32_f32 v116, v113
    v_cvt_rpi_i32_f32 v111, v111
    v_cvt_rpi_i32_f32 v112, v112
    v_and_b32 v90, 0xfff8, v90
    v_ashrrev_i32 v115, 31, v114
    v_ashrrev_i32 v117, 31, v116
    v_add_u32 v115, v115, v111
    v_add_u32 v117, 0x400000, v117
    v_mad_i64_i32 v[116:117], vcc, v112, s69, v[116:117]
    ds_add_u64 v90, v[114:115]
    ds_add_u64 v90, v[116:117] offset:50176
    s_mov_b64 exec, -1
    v_and_b32 v122, v3, v46
    v_mul_f32 v122, v2, v122
    s_waitcnt vmcnt(2)
    s_mov_b64 exec, s[50:51]
    v_lshlrev_b32 v102, 16, v92
    v_and_b32 v103, v3, v92
    v_lshlrev_b32 v104, 16, v93
    v_and_b32 v105, v3, v93
    v_mul_f32 v102, v122, v102
    v_mul_f32 v103, v122, v103
    v_mul_f32 v104, v122, v104
    v_mul_f32 v105, v122, v105
    v_lshrrev_b32 v92, 14, v23
    v_cvt_rpi_i32_f32 v106, v102
    v_cvt_rpi_i32_f32 v108, v105
    v_cvt_rpi_i32_f32 v103, v103
    v_cvt_rpi_i32_f32 v104, v104
    v_and_b32 v92, 0xfff8, v92
    v_ashrrev_i32 v107, 31, v106
    v_ashrrev_i32 v109, 31, v108
    v_add_u32 v107, v107, v103
    v_add_u32 v109, 0x400000, v109
    v_mad_i64_i32 v[108:109], vcc, v104, s69, v[108:109]
    ds_add_u64 v92, v[106:107]
    ds_add_u64 v92, v[108:109] offset:50176
    s_mov_b64 exec, -1
    v_lshlrev_b32 v122, 16, v47
    v_mul_f32 v122, v2, v122
    s_waitcnt vmcnt(1)
    s_mov_b64 exec, s[52:53]
    v_lshlrev_b32 v110, 16, v94
    v_and_b32 v111, v3, v94
    v_lshlrev_b32 v112, 16, v95
    v_and_b32 v113, v3, v95
    v_mul_f32 v110, v122, v110
    v_mul_f32 v111, v122, v111
    v_mul_f32 v112, v122, v112
    v_mul_f32 v113, v122, v113
    v_lshrrev_b32 v94, 14, v24
    v_cvt_rpi_i32_f32 v114, v110
    v_cvt_rpi_i32_f32 v116, v113
    v_cvt_rpi_i32_f32 v111, v111
    v_cvt_rpi_i32_f32 v112, v112
    v_and_b32 v94, 0xfff8, v94
    v_ashrrev_i32 v115, 31, v114
    v_ashrrev_i32 v117, 31, v116
    v_add_u32 v115, v115, v111
    v_add_u32 v117, 0x400000, v117
    v_mad_i64_i32 v[116:117], vcc, v112, s69, v[116:117]
    ds_add_u64 v94, v[114:115]
    ds_add_u64 v94, v[116:117] offset:50176
    s_mov_b64 exec, -1
    v_and_b32 v122, v3, v47
    v_mul_f32 v122, v2, v122
    s_waitcnt vmcnt(0)
    s_mov_b64 exec, s[54:55]
    v_lshlrev_b32 v102, 16, v96
    v_and_b32 v103, v3, v96
    v_lshlrev_b32 v104, 16, v97
    v_and_b32 v105, v3, v97
    v_mul_f32 v102, v122, v102
    v_mul_f32 v103, v122, v103
    v_mul_f32 v104, v122, v104
    v_mul_f32 v105, v122, v105
    v_lshrrev_b32 v96, 14, v25
    v_cvt_rpi_i32_f32 v106, v102
    v_cvt_rpi_i32_f32 v108, v105
    v_cvt_rpi_i32_f32 v103, v103
    v_cvt_rpi_i32_f32 v104, v104
    v_and_b32 v96, 0xfff8, v96
    v_ashrrev_i32 v107, 31, v106
    v_ashrrev_i32 v109, 31, v108
    v_add_u32 v107, v107, v103
    v_add_u32 v109, 0x400000, v109
    v_mad_i64_i32 v[108:109], vcc, v104, s69, v[108:109]
    ds_add_u64 v96, v[106:107]
    ds_add_u64 v96, v[108:109] offset:50176
    s_mov_b64 exec, -1
    v_add_u32 v126, 8192, v127
    v_cmp_gt_u32 s[40:41], s22, v126
    s_mov_b64 exec, s[40:41]
    v_lshlrev_b32 v124, 15, v26
    v_lshrrev_b32 v124, 12, v124
    buffer_load_dwordx2 v[82:83], v124, s[8:11], s25 offen
    s_mov_b64 exec, -1
    v_add_u32 v126, 8193, v127
    v_cmp_gt_u32 s[42:43], s22, v126
    s_mov_b64 exec, s[42:43]
    v_lshlrev_b32 v125, 15, v27
    v_lshrrev_b32 v125, 12, v125
    buffer_load_dwordx2 v[84:85], v125, s[8:11], s25 offen
    s_mov_b64 exec, -1
    v_add_u32 v126, 10240, v127
    v_cmp_gt_u32 s[44:45], s22, v126
    s_mov_b64 exec, s[44:45]
    v_lshlrev_b32 v124, 15, v28
    v_lshrrev_b32 v124, 12, v124
    buffer_load_dwordx2 v[86:87], v124, s[8:11], s25 offen
    s_mov_b64 exec, -1
    v_add_u32 v126, 10241, v127
    v_cmp_gt_u32 s[46:47], s22, v126
    s_mov_b64 exec, s[46:47]
    v_lshlrev_b32 v125, 15, v29
    v_lshrrev_b32 v125, 12, v125
    buffer_load_dwordx2 v[88:89], v125, s[8:11], s25 offen
    s_mov_b64 exec, -1
    v_add_u32 v126, 12288, v127
    v_cmp_gt_u32 s[48:49], s22, v126
    s_mov_b64 exec, s[48:49]
    v_lshlrev_b32 v124, 15, v30
    v_lshrrev_b32 v124, 12, v124
    buffer_load_dwordx2 v[90:91], v124, s[8:11], s25 offen
    s_mov_b64 exec, -1
    v_add_u32 v126, 12289, v127
    v_cmp_gt_u32 s[50:51], s22, v126
    s_mov_b64 exec, s[50:51]
    v_lshlrev_b32 v125, 15, v31
    v_lshrrev_b32 v125, 12, v125
    buffer_load_dwordx2 v[92:93], v125, s[8:11], s25 offen
    s_mov_b64 exec, -1
    v_add_u32 v126, 14336, v127
    v_cmp_gt_u32 s[52:53], s22, v126
    s_mov_b64 exec, s[52:53]
    v_lshlrev_b32 v124, 15, v32
    v_lshrrev_b32 v124, 12, v124
    buffer_load_dwordx2 v[94:95], v124, s[8:11], s25 offen
    s_mov_b64 exec, -1
    v_add_u32 v126, 14337, v127
    v_cmp_gt_u32 s[54:55], s22, v126
    s_mov_b64 exec, s[54:55]
    v_lshlrev_b32 v125, 15, v33
    v_lshrrev_b32 v125, 12, v125
    buffer_load_dwordx2 v[96:97], v125, s[8:11], s25 offen
    s_mov_b64 exec, -1
    v_lshlrev_b32 v122, 16, v48
    v_mul_f32 v122, v2, v122
    s_waitcnt vmcnt(7)
    s_mov_b64 exec, s[40:41]
    v_lshlrev_b32 v110, 16, v82
    v_and_b32 v111, v3, v82
    v_lshlrev_b32 v112, 16, v83
    v_and_b32 v113, v3, v83
    v_mul_f32 v110, v122, v110
    v_mul_f32 v111, v122, v111
    v_mul_f32 v112, v122, v112
    v_mul_f32 v113, v122, v113
    v_lshrrev_b32 v82, 14, v26
    v_cvt_rpi_i32_f32 v114, v110
    v_cvt_rpi_i32_f32 v116, v113
    v_cvt_rpi_i32_f32 v111, v111
    v_cvt_rpi_i32_f32 v112, v112
    v_and_b32 v82, 0xfff8, v82
    v_ashrrev_i32 v115, 31, v114
    v_ashrrev_i32 v117, 31, v116
    v_add_u32 v115, v115, v111
    v_add_u32 v117, 0x400000, v117
    v_mad_i64_i32 v[116:117], vcc, v112, s69, v[116:117]
    ds_add_u64 v82, v[114:115]
    ds_add_u64 v82, v[116:117] offset:50176
    s_mov_b64 exec, -1
    v_and_b32 v122, v3, v48
    v_mul_f32 v122, v2, v122
    s_waitcnt vmcnt(6)
    s_mov_b64 exec, s[42:43]
    v_lshlrev_b32 v102, 16, v84
    v_and_b32 v103, v3, v84
    v_lshlrev_b32 v104, 16, v85
    v_and_b32 v105, v3, v85
    v_mul_f32 v102, v122, v102
    v_mul_f32 v103, v122, v103
    v_mul_f32 v104, v122, v104
    v_mul_f32 v105, v122, v105
    v_lshrrev_b32 v84, 14, v27
    v_cvt_rpi_i32_f32 v106, v102
    v_cvt_rpi_i32_f32 v108, v105
    v_cvt_rpi_i32_f32 v103, v103
    v_cvt_rpi_i32_f32 v104, v104
    v_and_b32 v84, 0xfff8, v84
    v_ashrrev_i32 v107, 31, v106
    v_ashrrev_i32 v109, 31, v108
    v_add_u32 v107, v107, v103
    v_add_u32 v109, 0x400000, v109
    v_mad_i64_i32 v[108:109], vcc, v104, s69, v[108:109]
    ds_add_u64 v84, v[106:107]
    ds_add_u64 v84, v[108:109] offset:50176
    s_mov_b64 exec, -1
    v_lshlrev_b32 v122, 16, v49
    v_mul_f32 v122, v2, v122
    s_waitcnt vmcnt(5)
    s_mov_b64 exec, s[44:45]
    v_lshlrev_b32 v110, 16, v86
    v_and_b32 v111, v3, v86
    v_lshlrev_b32 v112, 16, v87
    v_and_b32 v113, v3, v87
    v_mul_f32 v110, v122, v110
    v_mul_f32 v111, v122, v111
    v_mul_f32 v112, v122, v112
    v_mul_f32 v113, v122, v113
    v_lshrrev_b32 v86, 14, v28
    v_cvt_rpi_i32_f32 v114, v110
    v_cvt_rpi_i32_f32 v116, v113
    v_cvt_rpi_i32_f32 v111, v111
    v_cvt_rpi_i32_f32 v112, v112
    v_and_b32 v86, 0xfff8, v86
    v_ashrrev_i32 v115, 31, v114
    v_ashrrev_i32 v117, 31, v116
    v_add_u32 v115, v115, v111
    v_add_u32 v117, 0x400000, v117
    v_mad_i64_i32 v[116:117], vcc, v112, s69, v[116:117]
    ds_add_u64 v86, v[114:115]
    ds_add_u64 v86, v[116:117] offset:50176
    s_mov_b64 exec, -1
    v_and_b32 v122, v3, v49
    v_mul_f32 v122, v2, v122
    s_waitcnt vmcnt(4)
    s_mov_b64 exec, s[46:47]
    v_lshlrev_b32 v102, 16, v88
    v_and_b32 v103, v3, v88
    v_lshlrev_b32 v104, 16, v89
    v_and_b32 v105, v3, v89
    v_mul_f32 v102, v122, v102
    v_mul_f32 v103, v122, v103
    v_mul_f32 v104, v122, v104
    v_mul_f32 v105, v122, v105
    v_lshrrev_b32 v88, 14, v29
    v_cvt_rpi_i32_f32 v106, v102
    v_cvt_rpi_i32_f32 v108, v105
    v_cvt_rpi_i32_f32 v103, v103
    v_cvt_rpi_i32_f32 v104, v104
    v_and_b32 v88, 0xfff8, v88
    v_ashrrev_i32 v107, 31, v106
    v_ashrrev_i32 v109, 31, v108
    v_add_u32 v107, v107, v103
    v_add_u32 v109, 0x400000, v109
    v_mad_i64_i32 v[108:109], vcc, v104, s69, v[108:109]
    ds_add_u64 v88, v[106:107]
    ds_add_u64 v88, v[108:109] offset:50176
    s_mov_b64 exec, -1
    v_lshlrev_b32 v122, 16, v50
    v_mul_f32 v122, v2, v122
    s_waitcnt vmcnt(3)
    s_mov_b64 exec, s[48:49]
    v_lshlrev_b32 v110, 16, v90
    v_and_b32 v111, v3, v90
    v_lshlrev_b32 v112, 16, v91
    v_and_b32 v113, v3, v91
    v_mul_f32 v110, v122, v110
    v_mul_f32 v111, v122, v111
    v_mul_f32 v112, v122, v112
    v_mul_f32 v113, v122, v113
    v_lshrrev_b32 v90, 14, v30
    v_cvt_rpi_i32_f32 v114, v110
    v_cvt_rpi_i32_f32 v116, v113
    v_cvt_rpi_i32_f32 v111, v111
    v_cvt_rpi_i32_f32 v112, v112
    v_and_b32 v90, 0xfff8, v90
    v_ashrrev_i32 v115, 31, v114
    v_ashrrev_i32 v117, 31, v116
    v_add_u32 v115, v115, v111
    v_add_u32 v117, 0x400000, v117
    v_mad_i64_i32 v[116:117], vcc, v112, s69, v[116:117]
    ds_add_u64 v90, v[114:115]
    ds_add_u64 v90, v[116:117] offset:50176
    s_mov_b64 exec, -1
    v_and_b32 v122, v3, v50
    v_mul_f32 v122, v2, v122
    s_waitcnt vmcnt(2)
    s_mov_b64 exec, s[50:51]
    v_lshlrev_b32 v102, 16, v92
    v_and_b32 v103, v3, v92
    v_lshlrev_b32 v104, 16, v93
    v_and_b32 v105, v3, v93
    v_mul_f32 v102, v122, v102
    v_mul_f32 v103, v122, v103
    v_mul_f32 v104, v122, v104
    v_mul_f32 v105, v122, v105
    v_lshrrev_b32 v92, 14, v31
    v_cvt_rpi_i32_f32 v106, v102
    v_cvt_rpi_i32_f32 v108, v105
    v_cvt_rpi_i32_f32 v103, v103
    v_cvt_rpi_i32_f32 v104, v104
    v_and_b32 v92, 0xfff8, v92
    v_ashrrev_i32 v107, 31, v106
    v_ashrrev_i32 v109, 31, v108
    v_add_u32 v107, v107, v103
    v_add_u32 v109, 0x400000, v109
    v_mad_i64_i32 v[108:109], vcc, v104, s69, v[108:109]
    ds_add_u64 v92, v[106:107]
    ds_add_u64 v92, v[108:109] offset:50176
    s_mov_b64 exec, -1
    v_lshlrev_b32 v122, 16, v51
    v_mul_f32 v122, v2, v122
    s_waitcnt vmcnt(1)
    s_mov_b64 exec, s[52:53]
    v_lshlrev_b32 v110, 16, v94
    v_and_b32 v111, v3, v94
    v_lshlrev_b32 v112, 16, v95
    v_and_b32 v113, v3, v95
    v_mul_f32 v110, v122, v110
    v_mul_f32 v111, v122, v111
    v_mul_f32 v112, v122, v112
    v_mul_f32 v113, v122, v113
    v_lshrrev_b32 v94, 14, v32
    v_cvt_rpi_i32_f32 v114, v110
    v_cvt_rpi_i32_f32 v116, v113
    v_cvt_rpi_i32_f32 v111, v111
    v_cvt_rpi_i32_f32 v112, v112
    v_and_b32 v94, 0xfff8, v94
    v_ashrrev_i32 v115, 31, v114
    v_ashrrev_i32 v117, 31, v116
    v_add_u32 v115, v115, v111
    v_add_u32 v117, 0x400000, v117
    v_mad_i64_i32 v[116:117], vcc, v112, s69, v[116:117]
    ds_add_u64 v94, v[114:115]
    ds_add_u64 v94, v[116:117] offset:50176
    s_mov_b64 exec, -1
    v_and_b32 v122, v3, v51
    v_mul_f32 v122, v2, v122
    s_waitcnt vmcnt(0)
    s_mov_b64 exec, s[54:55]
    v_lshlrev_b32 v102, 16, v96
    v_and_b32 v103, v3, v96
    v_lshlrev_b32 v104, 16, v97
    v_and_b32 v105, v3, v97
    v_mul_f32 v102, v122, v102
    v_mul_f32 v103, v122, v103
    v_mul_f32 v104, v122, v104
    v_mul_f32 v105, v122, v105
    v_lshrrev_b32 v96, 14, v33
    v_cvt_rpi_i32_f32 v106, v102
    v_cvt_rpi_i32_f32 v108, v105
    v_cvt_rpi_i32_f32 v103, v103
    v_cvt_rpi_i32_f32 v104, v104
    v_and_b32 v96, 0xfff8, v96
    v_ashrrev_i32 v107, 31, v106
    v_ashrrev_i32 v109, 31, v108
    v_add_u32 v107, v107, v103
    v_add_u32 v109, 0x400000, v109
    v_mad_i64_i32 v[108:109], vcc, v104, s69, v[108:109]
    ds_add_u64 v96, v[106:107]
    ds_add_u64 v96, v[108:109] offset:50176
    s_mov_b64 exec, -1
    v_add_u32 v126, 16384, v127
    v_cmp_gt_u32 s[40:41], s22, v126
    s_mov_b64 exec, s[40:41]
    v_lshlrev_b32 v124, 15, v34
    v_lshrrev_b32 v124, 12, v124
    buffer_load_dwordx2 v[82:83], v124, s[8:11], s25 offen
    s_mov_b64 exec, -1
    v_add_u32 v126, 16385, v127
    v_cmp_gt_u32 s[42:43], s22, v126
    s_mov_b64 exec, s[42:43]
    v_lshlrev_b32 v125, 15, v35
    v_lshrrev_b32 v125, 12, v125
    buffer_load_dwordx2 v[84:85], v125, s[8:11], s25 offen
    s_mov_b64 exec, -1
    v_add_u32 v126, 18432, v127
    v_cmp_gt_u32 s[44:45], s22, v126
    s_mov_b64 exec, s[44:45]
    v_lshlrev_b32 v124, 15, v36
    v_lshrrev_b32 v124, 12, v124
    buffer_load_dwordx2 v[86:87], v124, s[8:11], s25 offen
    s_mov_b64 exec, -1
    v_add_u32 v126, 18433, v127
    v_cmp_gt_u32 s[46:47], s22, v126
    s_mov_b64 exec, s[46:47]
    v_lshlrev_b32 v125, 15, v37
    v_lshrrev_b32 v125, 12, v125
    buffer_load_dwordx2 v[88:89], v125, s[8:11], s25 offen
    s_mov_b64 exec, -1
    v_add_u32 v126, 20480, v127
    v_cmp_gt_u32 s[48:49], s22, v126
    s_mov_b64 exec, s[48:49]
    v_lshlrev_b32 v124, 15, v38
    v_lshrrev_b32 v124, 12, v124
    buffer_load_dwordx2 v[90:91], v124, s[8:11], s25 offen
    s_mov_b64 exec, -1
    v_add_u32 v126, 20481, v127
    v_cmp_gt_u32 s[50:51], s22, v126
    s_mov_b64 exec, s[50:51]
    v_lshlrev_b32 v125, 15, v39
    v_lshrrev_b32 v125, 12, v125
    buffer_load_dwordx2 v[92:93], v125, s[8:11], s25 offen
    s_mov_b64 exec, -1
    v_add_u32 v126, 22528, v127
    v_cmp_gt_u32 s[52:53], s22, v126
    s_mov_b64 exec, s[52:53]
    v_lshlrev_b32 v124, 15, v40
    v_lshrrev_b32 v124, 12, v124
    buffer_load_dwordx2 v[94:95], v124, s[8:11], s25 offen
    s_mov_b64 exec, -1
    v_add_u32 v126, 22529, v127
    v_cmp_gt_u32 s[54:55], s22, v126
    s_mov_b64 exec, s[54:55]
    v_lshlrev_b32 v125, 15, v41
    v_lshrrev_b32 v125, 12, v125
    buffer_load_dwordx2 v[96:97], v125, s[8:11], s25 offen
    s_mov_b64 exec, -1
    v_lshlrev_b32 v122, 16, v52
    v_mul_f32 v122, v2, v122
    s_waitcnt vmcnt(7)
    s_mov_b64 exec, s[40:41]
    v_lshlrev_b32 v110, 16, v82
    v_and_b32 v111, v3, v82
    v_lshlrev_b32 v112, 16, v83
    v_and_b32 v113, v3, v83
    v_mul_f32 v110, v122, v110
    v_mul_f32 v111, v122, v111
    v_mul_f32 v112, v122, v112
    v_mul_f32 v113, v122, v113
    v_lshrrev_b32 v82, 14, v34
    v_cvt_rpi_i32_f32 v114, v110
    v_cvt_rpi_i32_f32 v116, v113
    v_cvt_rpi_i32_f32 v111, v111
    v_cvt_rpi_i32_f32 v112, v112
    v_and_b32 v82, 0xfff8, v82
    v_ashrrev_i32 v115, 31, v114
    v_ashrrev_i32 v117, 31, v116
    v_add_u32 v115, v115, v111
    v_add_u32 v117, 0x400000, v117
    v_mad_i64_i32 v[116:117], vcc, v112, s69, v[116:117]
    ds_add_u64 v82, v[114:115]
    ds_add_u64 v82, v[116:117] offset:50176
    s_mov_b64 exec, -1
    v_and_b32 v122, v3, v52
    v_mul_f32 v122, v2, v122
    s_waitcnt vmcnt(6)
    s_mov_b64 exec, s[42:43]
    v_lshlrev_b32 v102, 16, v84
    v_and_b32 v103, v3, v84
    v_lshlrev_b32 v104, 16, v85
    v_and_b32 v105, v3, v85
    v_mul_f32 v102, v122, v102
    v_mul_f32 v103, v122, v103
    v_mul_f32 v104, v122, v104
    v_mul_f32 v105, v122, v105
    v_lshrrev_b32 v84, 14, v35
    v_cvt_rpi_i32_f32 v106, v102
    v_cvt_rpi_i32_f32 v108, v105
    v_cvt_rpi_i32_f32 v103, v103
    v_cvt_rpi_i32_f32 v104, v104
    v_and_b32 v84, 0xfff8, v84
    v_ashrrev_i32 v107, 31, v106
    v_ashrrev_i32 v109, 31, v108
    v_add_u32 v107, v107, v103
    v_add_u32 v109, 0x400000, v109
    v_mad_i64_i32 v[108:109], vcc, v104, s69, v[108:109]
    ds_add_u64 v84, v[106:107]
    ds_add_u64 v84, v[108:109] offset:50176
    s_mov_b64 exec, -1
    v_lshlrev_b32 v122, 16, v53
    v_mul_f32 v122, v2, v122
    s_waitcnt vmcnt(5)
    s_mov_b64 exec, s[44:45]
    v_lshlrev_b32 v110, 16, v86
    v_and_b32 v111, v3, v86
    v_lshlrev_b32 v112, 16, v87
    v_and_b32 v113, v3, v87
    v_mul_f32 v110, v122, v110
    v_mul_f32 v111, v122, v111
    v_mul_f32 v112, v122, v112
    v_mul_f32 v113, v122, v113
    v_lshrrev_b32 v86, 14, v36
    v_cvt_rpi_i32_f32 v114, v110
    v_cvt_rpi_i32_f32 v116, v113
    v_cvt_rpi_i32_f32 v111, v111
    v_cvt_rpi_i32_f32 v112, v112
    v_and_b32 v86, 0xfff8, v86
    v_ashrrev_i32 v115, 31, v114
    v_ashrrev_i32 v117, 31, v116
    v_add_u32 v115, v115, v111
    v_add_u32 v117, 0x400000, v117
    v_mad_i64_i32 v[116:117], vcc, v112, s69, v[116:117]
    ds_add_u64 v86, v[114:115]
    ds_add_u64 v86, v[116:117] offset:50176
    s_mov_b64 exec, -1
    v_and_b32 v122, v3, v53
    v_mul_f32 v122, v2, v122
    s_waitcnt vmcnt(4)
    s_mov_b64 exec, s[46:47]
    v_lshlrev_b32 v102, 16, v88
    v_and_b32 v103, v3, v88
    v_lshlrev_b32 v104, 16, v89
    v_and_b32 v105, v3, v89
    v_mul_f32 v102, v122, v102
    v_mul_f32 v103, v122, v103
    v_mul_f32 v104, v122, v104
    v_mul_f32 v105, v122, v105
    v_lshrrev_b32 v88, 14, v37
    v_cvt_rpi_i32_f32 v106, v102
    v_cvt_rpi_i32_f32 v108, v105
    v_cvt_rpi_i32_f32 v103, v103
    v_cvt_rpi_i32_f32 v104, v104
    v_and_b32 v88, 0xfff8, v88
    v_ashrrev_i32 v107, 31, v106
    v_ashrrev_i32 v109, 31, v108
    v_add_u32 v107, v107, v103
    v_add_u32 v109, 0x400000, v109
    v_mad_i64_i32 v[108:109], vcc, v104, s69, v[108:109]
    ds_add_u64 v88, v[106:107]
    ds_add_u64 v88, v[108:109] offset:50176
    s_mov_b64 exec, -1
    v_lshlrev_b32 v122, 16, v54
    v_mul_f32 v122, v2, v122
    s_waitcnt vmcnt(3)
    s_mov_b64 exec, s[48:49]
    v_lshlrev_b32 v110, 16, v90
    v_and_b32 v111, v3, v90
    v_lshlrev_b32 v112, 16, v91
    v_and_b32 v113, v3, v91
    v_mul_f32 v110, v122, v110
    v_mul_f32 v111, v122, v111
    v_mul_f32 v112, v122, v112
    v_mul_f32 v113, v122, v113
    v_lshrrev_b32 v90, 14, v38
    v_cvt_rpi_i32_f32 v114, v110
    v_cvt_rpi_i32_f32 v116, v113
    v_cvt_rpi_i32_f32 v111, v111
    v_cvt_rpi_i32_f32 v112, v112
    v_and_b32 v90, 0xfff8, v90
    v_ashrrev_i32 v115, 31, v114
    v_ashrrev_i32 v117, 31, v116
    v_add_u32 v115, v115, v111
    v_add_u32 v117, 0x400000, v117
    v_mad_i64_i32 v[116:117], vcc, v112, s69, v[116:117]
    ds_add_u64 v90, v[114:115]
    ds_add_u64 v90, v[116:117] offset:50176
    s_mov_b64 exec, -1
    v_and_b32 v122, v3, v54
    v_mul_f32 v122, v2, v122
    s_waitcnt vmcnt(2)
    s_mov_b64 exec, s[50:51]
    v_lshlrev_b32 v102, 16, v92
    v_and_b32 v103, v3, v92
    v_lshlrev_b32 v104, 16, v93
    v_and_b32 v105, v3, v93
    v_mul_f32 v102, v122, v102
    v_mul_f32 v103, v122, v103
    v_mul_f32 v104, v122, v104
    v_mul_f32 v105, v122, v105
    v_lshrrev_b32 v92, 14, v39
    v_cvt_rpi_i32_f32 v106, v102
    v_cvt_rpi_i32_f32 v108, v105
    v_cvt_rpi_i32_f32 v103, v103
    v_cvt_rpi_i32_f32 v104, v104
    v_and_b32 v92, 0xfff8, v92
    v_ashrrev_i32 v107, 31, v106
    v_ashrrev_i32 v109, 31, v108
    v_add_u32 v107, v107, v103
    v_add_u32 v109, 0x400000, v109
    v_mad_i64_i32 v[108:109], vcc, v104, s69, v[108:109]
    ds_add_u64 v92, v[106:107]
    ds_add_u64 v92, v[108:109] offset:50176
    s_mov_b64 exec, -1
    v_lshlrev_b32 v122, 16, v55
    v_mul_f32 v122, v2, v122
    s_waitcnt vmcnt(1)
    s_mov_b64 exec, s[52:53]
    v_lshlrev_b32 v110, 16, v94
    v_and_b32 v111, v3, v94
    v_lshlrev_b32 v112, 16, v95
    v_and_b32 v113, v3, v95
    v_mul_f32 v110, v122, v110
    v_mul_f32 v111, v122, v111
    v_mul_f32 v112, v122, v112
    v_mul_f32 v113, v122, v113
    v_lshrrev_b32 v94, 14, v40
    v_cvt_rpi_i32_f32 v114, v110
    v_cvt_rpi_i32_f32 v116, v113
    v_cvt_rpi_i32_f32 v111, v111
    v_cvt_rpi_i32_f32 v112, v112
    v_and_b32 v94, 0xfff8, v94
    v_ashrrev_i32 v115, 31, v114
    v_ashrrev_i32 v117, 31, v116
    v_add_u32 v115, v115, v111
    v_add_u32 v117, 0x400000, v117
    v_mad_i64_i32 v[116:117], vcc, v112, s69, v[116:117]
    ds_add_u64 v94, v[114:115]
    ds_add_u64 v94, v[116:117] offset:50176
    s_mov_b64 exec, -1
    v_and_b32 v122, v3, v55
    v_mul_f32 v122, v2, v122
    s_waitcnt vmcnt(0)
    s_mov_b64 exec, s[54:55]
    v_lshlrev_b32 v102, 16, v96
    v_and_b32 v103, v3, v96
    v_lshlrev_b32 v104, 16, v97
    v_and_b32 v105, v3, v97
    v_mul_f32 v102, v122, v102
    v_mul_f32 v103, v122, v103
    v_mul_f32 v104, v122, v104
    v_mul_f32 v105, v122, v105
    v_lshrrev_b32 v96, 14, v41
    v_cvt_rpi_i32_f32 v106, v102
    v_cvt_rpi_i32_f32 v108, v105
    v_cvt_rpi_i32_f32 v103, v103
    v_cvt_rpi_i32_f32 v104, v104
    v_and_b32 v96, 0xfff8, v96
    v_ashrrev_i32 v107, 31, v106
    v_ashrrev_i32 v109, 31, v108
    v_add_u32 v107, v107, v103
    v_add_u32 v109, 0x400000, v109
    v_mad_i64_i32 v[108:109], vcc, v104, s69, v[108:109]
    ds_add_u64 v96, v[106:107]
    ds_add_u64 v96, v[108:109] offset:50176
    s_mov_b64 exec, -1
    v_add_u32 v126, 24576, v127
    v_cmp_gt_u32 s[40:41], s22, v126
    s_mov_b64 exec, s[40:41]
    v_lshlrev_b32 v124, 15, v42
    v_lshrrev_b32 v124, 12, v124
    buffer_load_dwordx2 v[82:83], v124, s[8:11], s25 offen
    s_mov_b64 exec, -1
    v_add_u32 v126, 24577, v127
    v_cmp_gt_u32 s[42:43], s22, v126
    s_mov_b64 exec, s[42:43]
    v_lshlrev_b32 v125, 15, v43
    v_lshrrev_b32 v125, 12, v125
    buffer_load_dwordx2 v[84:85], v125, s[8:11], s25 offen
    s_mov_b64 exec, -1
    v_lshlrev_b32 v122, 16, v56
    v_mul_f32 v122, v2, v122
    s_waitcnt vmcnt(1)
    s_mov_b64 exec, s[40:41]
    v_lshlrev_b32 v110, 16, v82
    v_and_b32 v111, v3, v82
    v_lshlrev_b32 v112, 16, v83
    v_and_b32 v113, v3, v83
    v_mul_f32 v110, v122, v110
    v_mul_f32 v111, v122, v111
    v_mul_f32 v112, v122, v112
    v_mul_f32 v113, v122, v113
    v_lshrrev_b32 v82, 14, v42
    v_cvt_rpi_i32_f32 v114, v110
    v_cvt_rpi_i32_f32 v116, v113
    v_cvt_rpi_i32_f32 v111, v111
    v_cvt_rpi_i32_f32 v112, v112
    v_and_b32 v82, 0xfff8, v82
    v_ashrrev_i32 v115, 31, v114
    v_ashrrev_i32 v117, 31, v116
    v_add_u32 v115, v115, v111
    v_add_u32 v117, 0x400000, v117
    v_mad_i64_i32 v[116:117], vcc, v112, s69, v[116:117]
    ds_add_u64 v82, v[114:115]
    ds_add_u64 v82, v[116:117] offset:50176
    s_mov_b64 exec, -1
    v_and_b32 v122, v3, v56
    v_mul_f32 v122, v2, v122
    s_waitcnt vmcnt(0)
    s_mov_b64 exec, s[42:43]
    v_lshlrev_b32 v102, 16, v84
    v_and_b32 v103, v3, v84
    v_lshlrev_b32 v104, 16, v85
    v_and_b32 v105, v3, v85
    v_mul_f32 v102, v122, v102
    v_mul_f32 v103, v122, v103
    v_mul_f32 v104, v122, v104
    v_mul_f32 v105, v122, v105
    v_lshrrev_b32 v84, 14, v43
    v_cvt_rpi_i32_f32 v106, v102
    v_cvt_rpi_i32_f32 v108, v105
    v_cvt_rpi_i32_f32 v103, v103
    v_cvt_rpi_i32_f32 v104, v104
    v_and_b32 v84, 0xfff8, v84
    v_ashrrev_i32 v107, 31, v106
    v_ashrrev_i32 v109, 31, v108
    v_add_u32 v107, v107, v103
    v_add_u32 v109, 0x400000, v109
    v_mad_i64_i32 v[108:109], vcc, v104, s69, v[108:109]
    ds_add_u64 v84, v[106:107]
    ds_add_u64 v84, v[108:109] offset:50176
    s_mov_b64 exec, -1
    s_mov_b32 s28, 0
    v_lshrrev_b32 v110, 16, v6
    v_cmp_lt_u32 s[64:65], 32, v110
P_tl0:
    s_cmp_eq_u64 s[64:65], 0
    s_cbranch_scc1 P_tl0_done
    s_ff1_i32_b64 s23, s[64:65]
    s_bitset0_b64 s[64:65], s23
    v_readlane_b32 s32, v6, s23
    s_cmp_lt_u32 s28, 4
    s_cselect_b32 s29, 64, 32
    s_add_u32 s28, s28, 1
    s_lshr_b32 s30, s32, 16
    s_and_b32 s32, s32, 0xffff
    s_lshl_b32 s32, s32, 2
    s_mul_i32 s31, s23, 2129920
    s_add_u32 s31, s31, s26
    s_add_u32 s31, s31, s32
P_tl0_piece:
    s_cmp_ge_u32 s29, s30
    s_cbranch_scc1 P_tl0_next
    v_mov_b32 v82, -1
    v_mov_b32 v83, -1
    v_lshlrev_b32 v110, 1, v1
    v_add_u32 v110, s29, v110
    v_cmp_gt_u32 s[40:41], s30, v110
    v_mul_u32_u24 v111, 6, v110
    s_mov_b64 exec, s[40:41]
    buffer_load_dwordx3 v[82:84], v111, s[4:7], s31 offen
    s_mov_b64 exec, -1
    s_waitcnt vmcnt(0)
    v_cmp_le_i32 s[40:41], 0, v82
    s_mov_b64 exec, s[40:41]
    v_lshlrev_b32 v124, 15, v82
    v_lshrrev_b32 v124, 12, v124
    buffer_load_dwordx2 v[86:87], v124, s[8:11], s25 offen
    s_mov_b64 exec, -1
    v_cmp_le_i32 s[42:43], 0, v83
    s_mov_b64 exec, s[42:43]
    v_lshlrev_b32 v124, 15, v83
    v_lshrrev_b32 v124, 12, v124
    buffer_load_dwordx2 v[88:89], v124, s[8:11], s25 offen
    s_mov_b64 exec, -1
    s_waitcnt vmcnt(0)
    v_lshlrev_b32 v122, 16, v84
    v_mul_f32 v122, v2, v122
    s_mov_b64 exec, s[40:41]
    v_lshlrev_b32 v110, 16, v86
    v_and_b32 v111, v3, v86
    v_lshlrev_b32 v112, 16, v87
    v_and_b32 v113, v3, v87
    v_mul_f32 v110, v122, v110
    v_mul_f32 v111, v122, v111
    v_mul_f32 v112, v122, v112
    v_mul_f32 v113, v122, v113
    v_lshrrev_b32 v86, 14, v82
    v_cvt_rpi_i32_f32 v114, v110
    v_cvt_rpi_i32_f32 v116, v113
    v_cvt_rpi_i32_f32 v111, v111
    v_cvt_rpi_i32_f32 v112, v112
    v_and_b32 v86, 0xfff8, v86
    v_ashrrev_i32 v115, 31, v114
    v_ashrrev_i32 v117, 31, v116
    v_add_u32 v115, v115, v111
    v_add_u32 v117, 0x400000, v117
    v_mad_i64_i32 v[116:117], vcc, v112, s69, v[116:117]
    ds_add_u64 v86, v[114:115]
    ds_add_u64 v86, v[116:117] offset:50176
    s_mov_b64 exec, -1
    v_and_b32 v122, v3, v84
    v_mul_f32 v122, v2, v122
    s_mov_b64 exec, s[42:43]
    v_lshlrev_b32 v110, 16, v88
    v_and_b32 v111, v3, v88
    v_lshlrev_b32 v112, 16, v89
    v_and_b32 v113, v3, v89
    v_mul_f32 v110, v122, v110
    v_mul_f32 v111, v122, v111
    v_mul_f32 v112, v122, v112
    v_mul_f32 v113, v122, v113
    v_lshrrev_b32 v88, 14, v83
    v_cvt_rpi_i32_f32 v114, v110
    v_cvt_rpi_i32_f32 v116, v113
    v_cvt_rpi_i32_f32 v111, v111
    v_cvt_rpi_i32_f32 v112, v112
    v_and_b32 v88, 0xfff8, v88
    v_ashrrev_i32 v115, 31, v114
    v_ashrrev_i32 v117, 31, v116
    v_add_u32 v115, v115, v111
    v_add_u32 v117, 0x400000, v117
    v_mad_i64_i32 v[116:117], vcc, v112, s69, v[116:117]
    ds_add_u64 v88, v[114:115]
    ds_add_u64 v88, v[116:117] offset:50176
    s_mov_b64 exec, -1
    s_add_u32 s29, s29, 128
    s_branch P_tl0_piece
P_tl0_next:
    s_branch P_tl0
P_tl0_done:
    v_lshrrev_b32 v110, 16, v10
    v_cmp_lt_u32 s[64:65], 32, v110
P_tl1:
    s_cmp_eq_u64 s[64:65], 0
    s_cbranch_scc1 P_tl1_done
    s_ff1_i32_b64 s23, s[64:65]
    s_bitset0_b64 s[64:65], s23
    v_readlane_b32 s32, v10, s23
    s_cmp_lt_u32 s28, 4
    s_cselect_b32 s29, 64, 32
    s_add_u32 s28, s28, 1
    s_lshr_b32 s30, s32, 16
    s_and_b32 s32, s32, 0xffff
    s_lshl_b32 s32, s32, 2
    s_add_u32 s23, s23, 64
    s_mul_i32 s31, s23, 2129920
    s_add_u32 s31, s31, s26
    s_add_u32 s31, s31, s32
P_tl1_piece:
    s_cmp_ge_u32 s29, s30
    s_cbranch_scc1 P_tl1_next
    v_mov_b32 v82, -1
    v_mov_b32 v83, -1
    v_lshlrev_b32 v110, 1, v1
    v_add_u32 v110, s29, v110
    v_cmp_gt_u32 s[40:41], s30, v110
    v_mul_u32_u24 v111, 6, v110
    s_mov_b64 exec, s[40:41]
    buffer_load_dwordx3 v[82:84], v111, s[4:7], s31 offen
    s_mov_b64 exec, -1
    s_waitcnt vmcnt(0)
    v_cmp_le_i32 s[40:41], 0, v82
    s_mov_b64 exec, s[40:41]
    v_lshlrev_b32 v124, 15, v82
    v_lshrrev_b32 v124, 12, v124
    buffer_load_dwordx2 v[86:87], v124, s[8:11], s25 offen
    s_mov_b64 exec, -1
    v_cmp_le_i32 s[42:43], 0, v83
    s_mov_b64 exec, s[42:43]
    v_lshlrev_b32 v124, 15, v83
    v_lshrrev_b32 v124, 12, v124
    buffer_load_dwordx2 v[88:89], v124, s[8:11], s25 offen
    s_mov_b64 exec, -1
    s_waitcnt vmcnt(0)
    v_lshlrev_b32 v122, 16, v84
    v_mul_f32 v122, v2, v122
    s_mov_b64 exec, s[40:41]
    v_lshlrev_b32 v110, 16, v86
    v_and_b32 v111, v3, v86
    v_lshlrev_b32 v112, 16, v87
    v_and_b32 v113, v3, v87
    v_mul_f32 v110, v122, v110
    v_mul_f32 v111, v122, v111
    v_mul_f32 v112, v122, v112
    v_mul_f32 v113, v122, v113
    v_lshrrev_b32 v86, 14, v82
    v_cvt_rpi_i32_f32 v114, v110
    v_cvt_rpi_i32_f32 v116, v113
    v_cvt_rpi_i32_f32 v111, v111
    v_cvt_rpi_i32_f32 v112, v112
    v_and_b32 v86, 0xfff8, v86
    v_ashrrev_i32 v115, 31, v114
    v_ashrrev_i32 v117, 31, v116
    v_add_u32 v115, v115, v111
    v_add_u32 v117, 0x400000, v117
    v_mad_i64_i32 v[116:117], vcc, v112, s69, v[116:117]
    ds_add_u64 v86, v[114:115]
    ds_add_u64 v86, v[116:117] offset:50176
    s_mov_b64 exec, -1
    v_and_b32 v122, v3, v84
    v_mul_f32 v122, v2, v122
    s_mov_b64 exec, s[42:43]
    v_lshlrev_b32 v110, 16, v88
    v_and_b32 v111, v3, v88
    v_lshlrev_b32 v112, 16, v89
    v_and_b32 v113, v3, v89
    v_mul_f32 v110, v122, v110
    v_mul_f32 v111, v122, v111
    v_mul_f32 v112, v122, v112
    v_mul_f32 v113, v122, v113
    v_lshrrev_b32 v88, 14, v83
    v_cvt_rpi_i32_f32 v114, v110
    v_cvt_rpi_i32_f32 v116, v113
    v_cvt_rpi_i32_f32 v111, v111
    v_cvt_rpi_i32_f32 v112, v112
    v_and_b32 v88, 0xfff8, v88
    v_ashrrev_i32 v115, 31, v114
    v_ashrrev_i32 v117, 31, v116
    v_add_u32 v115, v115, v111
    v_add_u32 v117, 0x400000, v117
    v_mad_i64_i32 v[116:117], vcc, v112, s69, v[116:117]
    ds_add_u64 v88, v[114:115]
    ds_add_u64 v88, v[116:117] offset:50176
    s_mov_b64 exec, -1
    s_add_u32 s29, s29, 128
    s_branch P_tl1_piece
P_tl1_next:
    s_branch P_tl1
P_tl1_done:
    s_cmp_eq_u32 s67, 0
    s_cbranch_scc1 P_nopf2
    v_add_u32 v126, 0, v17
    ds_bpermute_b32 v44, v126, v7
    v_mov_b32 v18, -1
    v_mov_b32 v19, -1
    v_add_u32 v127, 16, v17
    ds_bpermute_b32 v45, v127, v7
    v_mov_b32 v20, -1
    v_mov_b32 v21, -1
    v_add_u32 v126, 32, v17
    ds_bpermute_b32 v46, v126, v7
    v_mov_b32 v22, -1
    v_mov_b32 v23, -1
    v_add_u32 v127, 48, v17
    ds_bpermute_b32 v47, v127, v7
    v_mov_b32 v24, -1
    v_mov_b32 v25, -1
    v_add_u32 v126, 64, v17
    ds_bpermute_b32 v48, v126, v7
    v_mov_b32 v26, -1
    v_mov_b32 v27, -1
    v_add_u32 v127, 80, v17
    ds_bpermute_b32 v49, v127, v7
    v_mov_b32 v28, -1
    v_mov_b32 v29, -1
    v_add_u32 v126, 96, v17
    ds_bpermute_b32 v50, v126, v7
    v_mov_b32 v30, -1
    v_mov_b32 v31, -1
    v_add_u32 v127, 112, v17
    ds_bpermute_b32 v51, v127, v7
    v_mov_b32 v32, -1
    v_mov_b32 v33, -1
    v_add_u32 v126, 128, v17
    ds_bpermute_b32 v52, v126, v7
    v_mov_b32 v34, -1
    v_mov_b32 v35, -1
    v_add_u32 v127, 144, v17
    ds_bpermute_b32 v53, v127, v7
    v_mov_b32 v36, -1
    v_mov_b32 v37, -1
    v_add_u32 v126, 160, v17
    ds_bpermute_b32 v54, v126, v7
    v_mov_b32 v38, -1
    v_mov_b32 v39, -1
    v_add_u32 v127, 176, v17
    ds_bpermute_b32 v55, v127, v7
    v_mov_b32 v40, -1
    v_mov_b32 v41, -1
    v_add_u32 v126, 192, v17
    ds_bpermute_b32 v56, v126, v7
    v_mov_b32 v42, -1
    v_mov_b32 v43, -1
    s_waitcnt lgkmcnt(0)
    v_lshrrev_b32 v112, 16, v44
    v_and_b32 v113, 0xffff, v44
    v_add_u32 v114, 0, v15
    v_cmp_gt_u32 s[40:41], v112, v16
    v_lshl_add_u32 v114, v113, 2, v114
    s_and_b64 exec, s[40:41], s[74:75]
    buffer_load_dwordx2 v[18:19], v114, s[4:7], 0 offen
    buffer_load_dword v44, v114, s[4:7], 0 offen offset:8
    s_mov_b64 exec, -1
    v_lshrrev_b32 v115, 16, v45
    v_and_b32 v116, 0xffff, v45
    v_add_u32 v117, 8519680, v15
    v_cmp_gt_u32 s[42:43], v115, v16
    v_lshl_add_u32 v117, v116, 2, v117
    s_and_b64 exec, s[42:43], s[74:75]
    buffer_load_dwordx2 v[20:21], v117, s[4:7], 0 offen
    buffer_load_dword v45, v117, s[4:7], 0 offen offset:8
    s_mov_b64 exec, -1
    v_lshrrev_b32 v112, 16, v46
    v_and_b32 v113, 0xffff, v46
    v_add_u32 v114, 17039360, v15
    v_cmp_gt_u32 s[40:41], v112, v16
    v_lshl_add_u32 v114, v113, 2, v114
    s_and_b64 exec, s[40:41], s[74:75]
    buffer_load_dwordx2 v[22:23], v114, s[4:7], 0 offen
    buffer_load_dword v46, v114, s[4:7], 0 offen offset:8
    s_mov_b64 exec, -1
    v_lshrrev_b32 v115, 16, v47
    v_and_b32 v116, 0xffff, v47
    v_add_u32 v117, 25559040, v15
    v_cmp_gt_u32 s[42:43], v115, v16
    v_lshl_add_u32 v117, v116, 2, v117
    s_and_b64 exec, s[42:43], s[74:75]
    buffer_load_dwordx2 v[24:25], v117, s[4:7], 0 offen
    buffer_load_dword v47, v117, s[4:7], 0 offen offset:8
    s_mov_b64 exec, -1
    v_lshrrev_b32 v112, 16, v48
    v_and_b32 v113, 0xffff, v48
    v_add_u32 v114, 34078720, v15
    v_cmp_gt_u32 s[40:41], v112, v16
    v_lshl_add_u32 v114, v113, 2, v114
    s_and_b64 exec, s[40:41], s[74:75]
    buffer_load_dwordx2 v[26:27], v114, s[4:7], 0 offen
    buffer_load_dword v48, v114, s[4:7], 0 offen offset:8
    s_mov_b64 exec, -1
    v_lshrrev_b32 v115, 16, v49
    v_and_b32 v116, 0xffff, v49
    v_add_u32 v117, 42598400, v15
    v_cmp_gt_u32 s[42:43], v115, v16
    v_lshl_add_u32 v117, v116, 2, v117
    s_and_b64 exec, s[42:43], s[74:75]
    buffer_load_dwordx2 v[28:29], v117, s[4:7], 0 offen
    buffer_load_dword v49, v117, s[4:7], 0 offen offset:8
    s_mov_b64 exec, -1
    v_lshrrev_b32 v112, 16, v50
    v_and_b32 v113, 0xffff, v50
    v_add_u32 v114, 51118080, v15
    v_cmp_gt_u32 s[40:41], v112, v16
    v_lshl_add_u32 v114, v113, 2, v114
    s_and_b64 exec, s[40:41], s[74:75]
    buffer_load_dwordx2 v[30:31], v114, s[4:7], 0 offen
    buffer_load_dword v50, v114, s[4:7], 0 offen offset:8
    s_mov_b64 exec, -1
    v_lshrrev_b32 v115, 16, v51
    v_and_b32 v116, 0xffff, v51
    v_add_u32 v117, 59637760, v15
    v_cmp_gt_u32 s[42:43], v115, v16
    v_lshl_add_u32 v117, v116, 2, v117
    s_and_b64 exec, s[42:43], s[74:75]
    buffer_load_dwordx2 v[32:33], v117, s[4:7], 0 offen
    buffer_load_dword v51, v117, s[4:7], 0 offen offset:8
    s_mov_b64 exec, -1
    v_lshrrev_b32 v112, 16, v52
    v_and_b32 v113, 0xffff, v52
    v_add_u32 v114, 68157440, v15
    v_cmp_gt_u32 s[40:41], v112, v16
    v_lshl_add_u32 v114, v113, 2, v114
    s_and_b64 exec, s[40:41], s[74:75]
    buffer_load_dwordx2 v[34:35], v114, s[4:7], 0 offen
    buffer_load_dword v52, v114, s[4:7], 0 offen offset:8
    s_mov_b64 exec, -1
    v_lshrrev_b32 v115, 16, v53
    v_and_b32 v116, 0xffff, v53
    v_add_u32 v117, 76677120, v15
    v_cmp_gt_u32 s[42:43], v115, v16
    v_lshl_add_u32 v117, v116, 2, v117
    s_and_b64 exec, s[42:43], s[74:75]
    buffer_load_dwordx2 v[36:37], v117, s[4:7], 0 offen
    buffer_load_dword v53, v117, s[4:7], 0 offen offset:8
    s_mov_b64 exec, -1
    v_lshrrev_b32 v112, 16, v54
    v_and_b32 v113, 0xffff, v54
    v_add_u32 v114, 85196800, v15
    v_cmp_gt_u32 s[40:41], v112, v16
    v_lshl_add_u32 v114, v113, 2, v114
    s_and_b64 exec, s[40:41], s[74:75]
    buffer_load_dwordx2 v[38:39], v114, s[4:7], 0 offen
    buffer_load_dword v54, v114, s[4:7], 0 offen offset:8
    s_mov_b64 exec, -1
    v_lshrrev_b32 v115, 16, v55
    v_and_b32 v116, 0xffff, v55
    v_add_u32 v117, 93716480, v15
    v_cmp_gt_u32 s[42:43], v115, v16
    v_lshl_add_u32 v117, v116, 2, v117
    s_and_b64 exec, s[42:43], s[74:75]
    buffer_load_dwordx2 v[40:41], v117, s[4:7], 0 offen
    buffer_load_dword v55, v117, s[4:7], 0 offen offset:8
    s_mov_b64 exec, -1
    v_lshrrev_b32 v112, 16, v56
    v_and_b32 v113, 0xffff, v56
    v_add_u32 v114, 102236160, v15
    v_cmp_gt_u32 s[40:41], v112, v16
    v_lshl_add_u32 v114, v113, 2, v114
    s_and_b64 exec, s[40:41], s[74:75]
    buffer_load_dwordx2 v[42:43], v114, s[4:7], 0 offen
    buffer_load_dword v56, v114, s[4:7], 0 offen offset:8
    s_mov_b64 exec, -1
P_hist:
    s_waitcnt vmcnt(26)
    v_cmp_le_i32 s[44:45], 0, v58
    v_lshrrev_b32 v114, 5, v58
    v_and_b32 v114, 0xffc, v114
    v_add_u32 v114, 156000, v114
    s_mov_b64 exec, s[44:45]
    ds_add_u32 v114, v4
    s_mov_b64 exec, -1
    v_cmp_le_i32 s[46:47], 0, v59
    v_lshrrev_b32 v116, 5, v59
    v_and_b32 v116, 0xffc, v116
    v_add_u32 v116, 156000, v116
    s_mov_b64 exec, s[46:47]
    ds_add_u32 v116, v4
    s_mov_b64 exec, -1
    v_cmp_le_i32 s[40:41], 0, v60
    v_lshrrev_b32 v110, 5, v60
    v_and_b32 v110, 0xffc, v110
    v_add_u32 v110, 156000, v110
    s_mov_b64 exec, s[40:41]
    ds_add_u32 v110, v4
    s_mov_b64 exec, -1
    v_cmp_le_i32 s[42:43], 0, v61
    v_lshrrev_b32 v112, 5, v61
    v_and_b32 v112, 0xffc, v112
    v_add_u32 v112, 156000, v112
    s_mov_b64 exec, s[42:43]
    ds_add_u32 v112, v4
    s_mov_b64 exec, -1
    v_cmp_le_i32 s[44:45], 0, v62
    v_lshrrev_b32 v114, 5, v62
    v_and_b32 v114, 0xffc, v114
    v_add_u32 v114, 156000, v114
    s_mov_b64 exec, s[44:45]
    ds_add_u32 v114, v4
    s_mov_b64 exec, -1
    v_cmp_le_i32 s[46:47], 0, v63
    v_lshrrev_b32 v116, 5, v63
    v_and_b32 v116, 0xffc, v116
    v_add_u32 v116, 156000, v116
    s_mov_b64 exec, s[46:47]
    ds_add_u32 v116, v4
    s_mov_b64 exec, -1
    v_cmp_le_i32 s[40:41], 0, v64
    v_lshrrev_b32 v110, 5, v64
    v_and_b32 v110, 0xffc, v110
    v_add_u32 v110, 156000, v110
    s_mov_b64 exec, s[40:41]
    ds_add_u32 v110, v4
    s_mov_b64 exec, -1
    v_cmp_le_i32 s[42:43], 0, v65
    v_lshrrev_b32 v112, 5, v65
    v_and_b32 v112, 0xffc, v112
    v_add_u32 v112, 156000, v112
    s_mov_b64 exec, s[42:43]
    ds_add_u32 v112, v4
    s_mov_b64 exec, -1
    v_cmp_le_i32 s[44:45], 0, v66
    v_lshrrev_b32 v114, 5, v66
    v_and_b32 v114, 0xffc, v114
    v_add_u32 v114, 156000, v114
    s_mov_b64 exec, s[44:45]
    ds_add_u32 v114, v4
    s_mov_b64 exec, -1
    v_cmp_le_i32 s[46:47], 0, v67
    v_lshrrev_b32 v116, 5, v67
    v_and_b32 v116, 0xffc, v116
    v_add_u32 v116, 156000, v116
    s_mov_b64 exec, s[46:47]
    ds_add_u32 v116, v4
    s_mov_b64 exec, -1
    v_cmp_le_i32 s[40:41], 0, v68
    v_lshrrev_b32 v110, 5, v68
    v_and_b32 v110, 0xffc, v110
    v_add_u32 v110, 156000, v110
    s_mov_b64 exec, s[40:41]
    ds_add_u32 v110, v4
    s_mov_b64 exec, -1
    v_cmp_le_i32 s[42:43], 0, v69
    v_lshrrev_b32 v112, 5, v69
    v_and_b32 v112, 0xffc, v112
    v_add_u32 v112, 156000, v112
    s_mov_b64 exec, s[42:43]
    ds_add_u32 v112, v4
    s_mov_b64 exec, -1
    v_cmp_le_i32 s[44:45], 0, v70
    v_lshrrev_b32 v114, 5, v70
    v_and_b32 v114, 0xffc, v114
    v_add_u32 v114, 156000, v114
    s_mov_b64 exec, s[44:45]
    ds_add_u32 v114, v4
    s_mov_b64 exec, -1
    v_cmp_le_i32 s[46:47], 0, v71
    v_lshrrev_b32 v116, 5, v71
    v_and_b32 v116, 0xffc, v116
    v_add_u32 v116, 156000, v116
    s_mov_b64 exec, s[46:47]
    ds_add_u32 v116, v4
    s_mov_b64 exec, -1
    v_cmp_le_i32 s[40:41], 0, v72
    v_lshrrev_b32 v110, 5, v72
    v_and_b32 v110, 0xffc, v110
    v_add_u32 v110, 156000, v110
    s_mov_b64 exec, s[40:41]
    ds_add_u32 v110, v4
    s_mov_b64 exec, -1
    v_cmp_le_i32 s[42:43], 0, v73
    v_lshrrev_b32 v112, 5, v73
    v_and_b32 v112, 0xffc, v112
    v_add_u32 v112, 156000, v112
    s_mov_b64 exec, s[42:43]
    ds_add_u32 v112, v4
    s_mov_b64 exec, -1
    s_waitcnt vmcnt(24)
    v_cmp_le_i32 s[40:41], 0, v18
    v_lshrrev_b32 v110, 5, v18
    v_and_b32 v110, 0xffc, v110
    v_add_u32 v110, 156000, v110
    s_mov_b64 exec, s[40:41]
    ds_add_u32 v110, v4
    s_mov_b64 exec, -1
    v_cmp_le_i32 s[42:43], 0, v19
    v_lshrrev_b32 v112, 5, v19
    v_and_b32 v112, 0xffc, v112
    v_add_u32 v112, 156000, v112
    s_mov_b64 exec, s[42:43]
    ds_add_u32 v112, v4
    s_mov_b64 exec, -1
    s_waitcnt vmcnt(22)
    v_cmp_le_i32 s[44:45], 0, v20
    v_lshrrev_b32 v114, 5, v20
    v_and_b32 v114, 0xffc, v114
    v_add_u32 v114, 156000, v114
    s_mov_b64 exec, s[44:45]
    ds_add_u32 v114, v4
    s_mov_b64 exec, -1
    v_cmp_le_i32 s[46:47], 0, v21
    v_lshrrev_b32 v116, 5, v21
    v_and_b32 v116, 0xffc, v116
    v_add_u32 v116, 156000, v116
    s_mov_b64 exec, s[46:47]
    ds_add_u32 v116, v4
    s_mov_b64 exec, -1
    s_waitcnt vmcnt(20)
    v_cmp_le_i32 s[40:41], 0, v22
    v_lshrrev_b32 v110, 5, v22
    v_and_b32 v110, 0xffc, v110
    v_add_u32 v110, 156000, v110
    s_mov_b64 exec, s[40:41]
    ds_add_u32 v110, v4
    s_mov_b64 exec, -1
    v_cmp_le_i32 s[42:43], 0, v23
    v_lshrrev_b32 v112, 5, v23
    v_and_b32 v112, 0xffc, v112
    v_add_u32 v112, 156000, v112
    s_mov_b64 exec, s[42:43]
    ds_add_u32 v112, v4
    s_mov_b64 exec, -1
    s_waitcnt vmcnt(18)
    v_cmp_le_i32 s[44:45], 0, v24
    v_lshrrev_b32 v114, 5, v24
    v_and_b32 v114, 0xffc, v114
    v_add_u32 v114, 156000, v114
    s_mov_b64 exec, s[44:45]
    ds_add_u32 v114, v4
    s_mov_b64 exec, -1
    v_cmp_le_i32 s[46:47], 0, v25
    v_lshrrev_b32 v116, 5, v25
    v_and_b32 v116, 0xffc, v116
    v_add_u32 v116, 156000, v116
    s_mov_b64 exec, s[46:47]
    ds_add_u32 v116, v4
    s_mov_b64 exec, -1
    s_waitcnt vmcnt(16)
    v_cmp_le_i32 s[40:41], 0, v26
    v_lshrrev_b32 v110, 5, v26
    v_and_b32 v110, 0xffc, v110
    v_add_u32 v110, 156000, v110
    s_mov_b64 exec, s[40:41]
    ds_add_u32 v110, v4
    s_mov_b64 exec, -1
    v_cmp_le_i32 s[42:43], 0, v27
    v_lshrrev_b32 v112, 5, v27
    v_and_b32 v112, 0xffc, v112
    v_add_u32 v112, 156000, v112
    s_mov_b64 exec, s[42:43]
    ds_add_u32 v112, v4
    s_mov_b64 exec, -1
    s_waitcnt vmcnt(14)
    v_cmp_le_i32 s[44:45], 0, v28
    v_lshrrev_b32 v114, 5, v28
    v_and_b32 v114, 0xffc, v114
    v_add_u32 v114, 156000, v114
    s_mov_b64 exec, s[44:45]
    ds_add_u32 v114, v4
    s_mov_b64 exec, -1
    v_cmp_le_i32 s[46:47], 0, v29
    v_lshrrev_b32 v116, 5, v29
    v_and_b32 v116, 0xffc, v116
    v_add_u32 v116, 156000, v116
    s_mov_b64 exec, s[46:47]
    ds_add_u32 v116, v4
    s_mov_b64 exec, -1
    s_waitcnt vmcnt(12)
    v_cmp_le_i32 s[40:41], 0, v30
    v_lshrrev_b32 v110, 5, v30
    v_and_b32 v110, 0xffc, v110
    v_add_u32 v110, 156000, v110
    s_mov_b64 exec, s[40:41]
    ds_add_u32 v110, v4
    s_mov_b64 exec, -1
    v_cmp_le_i32 s[42:43], 0, v31
    v_lshrrev_b32 v112, 5, v31
    v_and_b32 v112, 0xffc, v112
    v_add_u32 v112, 156000, v112
    s_mov_b64 exec, s[42:43]
    ds_add_u32 v112, v4
    s_mov_b64 exec, -1
    s_waitcnt vmcnt(10)
    v_cmp_le_i32 s[44:45], 0, v32
    v_lshrrev_b32 v114, 5, v32
    v_and_b32 v114, 0xffc, v114
    v_add_u32 v114, 156000, v114
    s_mov_b64 exec, s[44:45]
    ds_add_u32 v114, v4
    s_mov_b64 exec, -1
    v_cmp_le_i32 s[46:47], 0, v33
    v_lshrrev_b32 v116, 5, v33
    v_and_b32 v116, 0xffc, v116
    v_add_u32 v116, 156000, v116
    s_mov_b64 exec, s[46:47]
    ds_add_u32 v116, v4
    s_mov_b64 exec, -1
    s_waitcnt vmcnt(8)
    v_cmp_le_i32 s[40:41], 0, v34
    v_lshrrev_b32 v110, 5, v34
    v_and_b32 v110, 0xffc, v110
    v_add_u32 v110, 156000, v110
    s_mov_b64 exec, s[40:41]
    ds_add_u32 v110, v4
    s_mov_b64 exec, -1
    v_cmp_le_i32 s[42:43], 0, v35
    v_lshrrev_b32 v112, 5, v35
    v_and_b32 v112, 0xffc, v112
    v_add_u32 v112, 156000, v112
    s_mov_b64 exec, s[42:43]
    ds_add_u32 v112, v4
    s_mov_b64 exec, -1
    s_waitcnt vmcnt(6)
    v_cmp_le_i32 s[44:45], 0, v36
    v_lshrrev_b32 v114, 5, v36
    v_and_b32 v114, 0xffc, v114
    v_add_u32 v114, 156000, v114
    s_mov_b64 exec, s[44:45]
    ds_add_u32 v114, v4
    s_mov_b64 exec, -1
    v_cmp_le_i32 s[46:47], 0, v37
    v_lshrrev_b32 v116, 5, v37
    v_and_b32 v116, 0xffc, v116
    v_add_u32 v116, 156000, v116
    s_mov_b64 exec, s[46:47]
    ds_add_u32 v116, v4
    s_mov_b64 exec, -1
    s_waitcnt vmcnt(4)
    v_cmp_le_i32 s[40:41], 0, v38
    v_lshrrev_b32 v110, 5, v38
    v_and_b32 v110, 0xffc, v110
    v_add_u32 v110, 156000, v110
    s_mov_b64 exec, s[40:41]
    ds_add_u32 v110, v4
    s_mov_b64 exec, -1
    v_cmp_le_i32 s[42:43], 0, v39
    v_lshrrev_b32 v112, 5, v39
    v_and_b32 v112, 0xffc, v112
    v_add_u32 v112, 156000, v112
    s_mov_b64 exec, s[42:43]
    ds_add_u32 v112, v4
    s_mov_b64 exec, -1
    s_waitcnt vmcnt(2)
    v_cmp_le_i32 s[44:45], 0, v40
    v_lshrrev_b32 v114, 5, v40
    v_and_b32 v114, 0xffc, v114
    v_add_u32 v114, 156000, v114
    s_mov_b64 exec, s[44:45]
    ds_add_u32 v114, v4
    s_mov_b64 exec, -1
    v_cmp_le_i32 s[46:47], 0, v41
    v_lshrrev_b32 v116, 5, v41
    v_and_b32 v116, 0xffc, v116
    v_add_u32 v116, 156000, v116
    s_mov_b64 exec, s[46:47]
    ds_add_u32 v116, v4
    s_mov_b64 exec, -1
    s_waitcnt vmcnt(0)
    v_cmp_le_i32 s[40:41], 0, v42
    v_lshrrev_b32 v110, 5, v42
    v_and_b32 v110, 0xffc, v110
    v_add_u32 v110, 156000, v110
    s_mov_b64 exec, s[40:41]
    ds_add_u32 v110, v4
    s_mov_b64 exec, -1
    v_cmp_le_i32 s[42:43], 0, v43
    v_lshrrev_b32 v112, 5, v43
    v_and_b32 v112, 0xffc, v112
    v_add_u32 v112, 156000, v112
    s_mov_b64 exec, s[42:43]
    ds_add_u32 v112, v4
    s_mov_b64 exec, -1
P_nopf2:
    s_waitcnt lgkmcnt(0)
    s_barrier
    s_cmp_eq_u32 s67, 2
    s_cbranch_scc1 P_quarter
    s_sub_u32 s66, s66, 1
    s_cmp_eq_u32 s66, 0
    s_cbranch_scc1 P_qdone
    v_lshlrev_b32 v110, 4, v0
    ds_read_b128 v[82:85], v110 offset:0
    ds_read_b128 v[86:89], v110 offset:16384
    ds_read_b128 v[90:93], v110 offset:32768
    ds_read_b128 v[94:97], v110 offset:49152
    v_add_u32 v110, 65536, v110
    ds_read_b128 v[98:101], v110 offset:0
    ds_read_b128 v[102:105], v110 offset:16384
    v_cmp_gt_u32 vcc, 128, v0
    s_and_saveexec_b64 s[34:35], vcc
    ds_read_b128 v[106:109], v110 offset:32768
    s_mov_b64 exec, s[34:35]
    v_mov_b32 v6, v7
    v_mov_b32 v10, v11
    v_mov_b32 v7, v8
    v_mov_b32 v11, v12
    v_mov_b32 v8, v9
    v_mov_b32 v12, v13
    s_add_u32 s25, s25, 1600000
    s_waitcnt lgkmcnt(0)
    s_branch P_quarter
P_qdone:
    s_mul_i32 s74, s17, 50176
    s_add_u32 s74, s74, 200000000
    v_mov_b32 v28, 0
    v_mov_b32 v29, 0
    s_mov_b32 s28, 0
P_dec:
    v_add_u32 v18, s28, v0
    v_cmp_gt_u32 vcc, 6272, v18
    s_and_saveexec_b64 s[34:35], vcc
    v_lshlrev_b32 v30, 3, v18
    ds_read_b64 v[20:21], v30
    ds_read_b64 v[22:23], v30 offset:50176
    v_lshlrev_b32 v18, 3, v18
    s_waitcnt lgkmcnt(0)
    v_ashrrev_i32 v30, 31, v20
    v_sub_u32 v21, v21, v30
    v_add_u32 v31, 0x200000, v23
    v_lshrrev_b32 v31, 22, v31
    v_lshlrev_b32 v32, 5, v22
    v_ashrrev_i32 v32, 5, v32
    v_ashrrev_i32 v33, 31, v32
    v_sub_co_u32 v22, vcc, v22, v32
    s_nop 1
    v_subb_co_u32 v23, vcc, v23, v33, vcc
    v_alignbit_b32 v33, v23, v22, 27
    v_lshlrev_b32 v33, 5, v33
    v_ashrrev_i32 v33, 5, v33
    v_add_u32 v28, v28, v31
    v_max_u32 v29, v29, v31
    v_cvt_f32_i32 v24, v20
    v_cvt_f32_i32 v25, v21
    v_cvt_f32_i32 v26, v33
    v_cvt_f32_i32 v27, v32
    v_mul_f32 v24, s20, v24
    v_mul_f32 v25, s20, v25
    v_mul_f32 v26, s20, v26
    v_mul_f32 v27, s20, v27
    v_cvt_pk_bf16_f32 v24, v24, v25
    v_cvt_pk_bf16_f32 v25, v26, v27
    buffer_store_dwordx2 v[24:25], v18, s[4:7], s74 offen sc1
    s_mov_b64 exec, s[34:35]
    s_add_u32 s28, s28, 1024
    s_cmp_lt_u32 s28, 6272
    s_cbranch_scc1 P_dec
    s_nop 1
    v_add_u32_dpp v28, v28, v28 row_shr:1 row_mask:0xf bank_mask:0xf
    s_nop 1
    v_add_u32_dpp v28, v28, v28 row_shr:2 row_mask:0xf bank_mask:0xf
    s_nop 1
    v_add_u32_dpp v28, v28, v28 row_shr:4 row_mask:0xf bank_mask:0xf
    s_nop 1
    v_add_u32_dpp v28, v28, v28 row_shr:8 row_mask:0xf bank_mask:0xf
    s_nop 1
    v_add_u32_dpp v28, v28, v28 row_bcast:15 row_mask:0xa bank_mask:0xf
    s_nop 1
    v_add_u32_dpp v28, v28, v28 row_bcast:31 row_mask:0xc bank_mask:0xf
    s_nop 1
    v_max_u32_dpp v29, v29, v29 row_shr:1 row_mask:0xf bank_mask:0xf
    s_nop 1
    v_max_u32_dpp v29, v29, v29 row_shr:2 row_mask:0xf bank_mask:0xf
    s_nop 1
    v_max_u32_dpp v29, v29, v29 row_shr:4 row_mask:0xf bank_mask:0xf
    s_nop 1
    v_max_u32_dpp v29, v29, v29 row_shr:8 row_mask:0xf bank_mask:0xf
    s_nop 1
    v_max_u32_dpp v29, v29, v29 row_bcast:15 row_mask:0xa bank_mask:0xf
    s_nop 1
    v_max_u32_dpp v29, v29, v29 row_bcast:31 row_mask:0xc bank_mask:0xf
    v_mov_b32 v30, 159160
    s_mov_b32 exec_lo, 0
    s_mov_b32 exec_hi, 0x80000000
    ds_add_u32 v30, v28
    ds_max_u32 v30, v29 offset:4
    s_mov_b64 exec, -1
    s_waitcnt lgkmcnt(0)
    s_barrier
    ds_read_b64 v[20:21], v30
    s_waitcnt lgkmcnt(0)
    v_readfirstlane_b32 s23, v20
    v_readfirstlane_b32 s24, v21
    s_cmp_lg_u32 s23, s68
    s_cbranch_scc1 P_robust
    s_cmp_gt_u32 s24, 256
    s_cbranch_scc1 P_robust
    s_branch P_end_rt
P_robust:
    s_waitcnt vmcnt(0) lgkmcnt(0)
    v_mov_b32 v2, s71
    s_mul_i32 s74, s17, 50176
    s_add_u32 s74, s74, 200000000
    v_lshlrev_b32 v110, 4, v1
    v_add_u32 v110, s16, v110
    s_mov_b32 s23, 133120
    v_mul_lo_u32 v110, v110, s23
    s_lshl_b32 s24, s17, 4
    v_add_u32 v110, s24, v110
    v_add_u32 v111, 136314880, v110
    buffer_load_dwordx4 v[6:9], v110, s[12:15], 0 offen
    buffer_load_dwordx4 v[10:13], v111, s[12:15], 0 offen
    s_barrier
    v_mov_b32 v82, 0
    v_mov_b32 v83, 0
    v_mov_b32 v84, 0
    v_mov_b32 v85, 0
    v_mov_b32 v86, 0
    v_mov_b32 v87, 0
    v_mov_b32 v88, 0
    v_mov_b32 v89, 0
    v_mov_b32 v90, 0
    v_mov_b32 v91, 0
    v_mov_b32 v92, 0
    v_mov_b32 v93, 0
    v_mov_b32 v94, 0
    v_mov_b32 v95, 0
    v_mov_b32 v96, 0
    v_mov_b32 v97, 0
    v_mov_b32 v98, 0
    v_mov_b32 v99, 0
    v_mov_b32 v100, 0
    v_mov_b32 v101, 0
    v_mov_b32 v102, 0
    v_mov_b32 v103, 0
    v_mov_b32 v104, 0
    v_mov_b32 v105, 0
    v_mov_b32 v106, 0
    v_mov_b32 v107, 0
    v_mov_b32 v108, 0
    v_mov_b32 v109, 0
    v_lshlrev_b32 v110, 4, v0
    ds_write_b128 v110, v[82:85] offset:0
    ds_write_b128 v110, v[86:89] offset:16384
    ds_write_b128 v110, v[90:93] offset:32768
    ds_write_b128 v110, v[94:97] offset:49152
    v_add_u32 v110, 65536, v110
    ds_write_b128 v110, v[98:101] offset:0
    ds_write_b128 v110, v[102:105] offset:16384
    v_cmp_gt_u32 vcc, 128, v0
    s_and_saveexec_b64 s[34:35], vcc
    ds_write_b128 v110, v[106:109] offset:32768
    s_mov_b64 exec, s[34:35]
    s_waitcnt vmcnt(0) lgkmcnt(0)
    s_barrier
    s_mov_b32 s25, s70
    s_mov_b32 s66, 4
P_rb_q0:
    s_mov_b32 s28, 0
P_rb_run0:
    s_cmp_lt_u32 s28, 64
    s_cbranch_scc0 P_rb_hb0
    v_readlane_b32 s32, v6, s28
    s_branch P_rb_h0
P_rb_hb0:
    v_readlane_b32 s32, v10, s28
P_rb_h0:
    s_mov_b32 s23, s28
    s_lshr_b32 s30, s32, 16
    s_and_b32 s32, s32, 0xffff
    s_lshl_b32 s32, s32, 2
    s_mul_i32 s31, s23, 2129920
    s_add_u32 s31, s31, s26
    s_add_u32 s31, s31, s32
    s_mov_b32 s29, 0
P_rb0_piece:
    s_cmp_ge_u32 s29, s30
    s_cbranch_scc1 P_rb0_next
    v_mov_b32 v18, -1
    v_mov_b32 v19, -1
    v_lshlrev_b32 v110, 1, v1
    v_add_u32 v110, s29, v110
    v_cmp_gt_u32 s[40:41], s30, v110
    v_mul_u32_u24 v111, 6, v110
    s_mov_b64 exec, s[40:41]
    buffer_load_dwordx3 v[18:20], v111, s[4:7], s31 offen
    s_mov_b64 exec, -1
    s_waitcnt vmcnt(0)
    v_cmp_le_i32 s[40:41], 0, v18
    s_mov_b64 exec, s[40:41]
    v_lshlrev_b32 v124, 15, v18
    v_lshrrev_b32 v124, 12, v124
    buffer_load_dwordx2 v[22:23], v124, s[8:11], s25 offen
    s_mov_b64 exec, -1
    v_cmp_le_i32 s[42:43], 0, v19
    s_mov_b64 exec, s[42:43]
    v_lshlrev_b32 v124, 15, v19
    v_lshrrev_b32 v124, 12, v124
    buffer_load_dwordx2 v[24:25], v124, s[8:11], s25 offen
    s_mov_b64 exec, -1
    s_waitcnt vmcnt(0)
    v_lshlrev_b32 v122, 16, v20
    v_mul_f32 v122, v2, v122
    s_mov_b64 exec, s[40:41]
    v_lshlrev_b32 v110, 16, v22
    v_and_b32 v112, v3, v22
    v_mul_f32 v110, v122, v110
    v_mul_f32 v112, v122, v112
    v_lshrrev_b32 v22, 14, v18
    v_cvt_i32_f32 v110, v110
    v_cvt_i32_f32 v112, v112
    v_and_b32 v22, 0xfff8, v22
    v_ashrrev_i32 v111, 31, v110
    v_ashrrev_i32 v113, 31, v112
    ds_add_u64 v22, v[110:111]
    ds_add_u64 v22, v[112:113] offset:50176
    s_mov_b64 exec, -1
    v_and_b32 v122, v3, v20
    v_mul_f32 v122, v2, v122
    s_mov_b64 exec, s[42:43]
    v_lshlrev_b32 v110, 16, v24
    v_and_b32 v112, v3, v24
    v_mul_f32 v110, v122, v110
    v_mul_f32 v112, v122, v112
    v_lshrrev_b32 v24, 14, v19
    v_cvt_i32_f32 v110, v110
    v_cvt_i32_f32 v112, v112
    v_and_b32 v24, 0xfff8, v24
    v_ashrrev_i32 v111, 31, v110
    v_ashrrev_i32 v113, 31, v112
    ds_add_u64 v24, v[110:111]
    ds_add_u64 v24, v[112:113] offset:50176
    s_mov_b64 exec, -1
    s_add_u32 s29, s29, 128
    s_branch P_rb0_piece
P_rb0_next:
    s_add_u32 s28, s28, 1
    s_cmp_lt_u32 s28, 80
    s_cbranch_scc1 P_rb_run0
    v_mov_b32 v6, v7
    v_mov_b32 v10, v11
    v_mov_b32 v7, v8
    v_mov_b32 v11, v12
    v_mov_b32 v8, v9
    v_mov_b32 v12, v13
    s_add_u32 s25, s25, 1600000
    s_sub_u32 s66, s66, 1
    s_cmp_lg_u32 s66, 0
    s_cbranch_scc1 P_rb_q0
    s_waitcnt lgkmcnt(0)
    s_barrier
    s_mov_b32 s76, 0
    s_mov_b32 s77, 0x41f00000
    s_mov_b32 s28, 0
P_rb_out0:
    v_add_u32 v18, s28, v0
    v_cmp_gt_u32 vcc, 6272, v18
    s_and_saveexec_b64 s[34:35], vcc
    v_lshlrev_b32 v30, 3, v18
    ds_read_b64 v[20:21], v30
    ds_read_b64 v[22:23], v30 offset:50176
    v_lshlrev_b32 v18, 3, v18
    s_waitcnt lgkmcnt(0)
    v_cvt_f64_i32 v[30:31], v21
    v_cvt_f64_u32 v[32:33], v20
    v_fma_f64 v[30:31], v[30:31], s[76:77], v[32:33]
    v_cvt_f32_f64 v24, v[30:31]
    v_mul_f32 v24, s72, v24
    v_cvt_f64_i32 v[30:31], v23
    v_cvt_f64_u32 v[32:33], v22
    v_fma_f64 v[30:31], v[30:31], s[76:77], v[32:33]
    v_cvt_f32_f64 v25, v[30:31]
    v_mul_f32 v25, s72, v25
    v_cvt_pk_bf16_f32 v24, v24, v25
    buffer_store_dword v24, v18, s[4:7], s74 offen offset:0
    s_mov_b64 exec, s[34:35]
    s_add_u32 s28, s28, 1024
    s_cmp_lt_u32 s28, 6272
    s_cbranch_scc1 P_rb_out0
    v_lshlrev_b32 v110, 4, v1
    v_add_u32 v110, s16, v110
    s_mov_b32 s23, 133120
    v_mul_lo_u32 v110, v110, s23
    s_lshl_b32 s24, s17, 4
    v_add_u32 v110, s24, v110
    v_add_u32 v111, 136314880, v110
    buffer_load_dwordx4 v[6:9], v110, s[12:15], 0 offen
    buffer_load_dwordx4 v[10:13], v111, s[12:15], 0 offen
    s_barrier
    v_mov_b32 v82, 0
    v_mov_b32 v83, 0
    v_mov_b32 v84, 0
    v_mov_b32 v85, 0
    v_mov_b32 v86, 0
    v_mov_b32 v87, 0
    v_mov_b32 v88, 0
    v_mov_b32 v89, 0
    v_mov_b32 v90, 0
    v_mov_b32 v91, 0
    v_mov_b32 v92, 0
    v_mov_b32 v93, 0
    v_mov_b32 v94, 0
    v_mov_b32 v95, 0
    v_mov_b32 v96, 0
    v_mov_b32 v97, 0
    v_mov_b32 v98, 0
    v_mov_b32 v99, 0
    v_mov_b32 v100, 0
    v_mov_b32 v101, 0
    v_mov_b32 v102, 0
    v_mov_b32 v103, 0
    v_mov_b32 v104, 0
    v_mov_b32 v105, 0
    v_mov_b32 v106, 0
    v_mov_b32 v107, 0
    v_mov_b32 v108, 0
    v_mov_b32 v109, 0
    v_lshlrev_b32 v110, 4, v0
    ds_write_b128 v110, v[82:85] offset:0
    ds_write_b128 v110, v[86:89] offset:16384
    ds_write_b128 v110, v[90:93] offset:32768
    ds_write_b128 v110, v[94:97] offset:49152
    v_add_u32 v110, 65536, v110
    ds_write_b128 v110, v[98:101] offset:0
    ds_write_b128 v110, v[102:105] offset:16384
    v_cmp_gt_u32 vcc, 128, v0
    s_and_saveexec_b64 s[34:35], vcc
    ds_write_b128 v110, v[106:109] offset:32768
    s_mov_b64 exec, s[34:35]
    s_waitcnt vmcnt(0) lgkmcnt(0)
    s_barrier
    s_mov_b32 s25, s70
    s_mov_b32 s66, 4
P_rb_q1:
    s_mov_b32 s28, 0
P_rb_run1:
    s_cmp_lt_u32 s28, 64
    s_cbranch_scc0 P_rb_hb1
    v_readlane_b32 s32, v6, s28
    s_branch P_rb_h1
P_rb_hb1:
    v_readlane_b32 s32, v10, s28
P_rb_h1:
    s_mov_b32 s23, s28
    s_lshr_b32 s30, s32, 16
    s_and_b32 s32, s32, 0xffff
    s_lshl_b32 s32, s32, 2
    s_mul_i32 s31, s23, 2129920
    s_add_u32 s31, s31, s26
    s_add_u32 s31, s31, s32
    s_mov_b32 s29, 0
P_rb1_piece:
    s_cmp_ge_u32 s29, s30
    s_cbranch_scc1 P_rb1_next
    v_mov_b32 v18, -1
    v_mov_b32 v19, -1
    v_lshlrev_b32 v110, 1, v1
    v_add_u32 v110, s29, v110
    v_cmp_gt_u32 s[40:41], s30, v110
    v_mul_u32_u24 v111, 6, v110
    s_mov_b64 exec, s[40:41]
    buffer_load_dwordx3 v[18:20], v111, s[4:7], s31 offen
    s_mov_b64 exec, -1
    s_waitcnt vmcnt(0)
    v_cmp_le_i32 s[40:41], 0, v18
    s_mov_b64 exec, s[40:41]
    v_lshlrev_b32 v124, 15, v18
    v_lshrrev_b32 v124, 12, v124
    buffer_load_dwordx2 v[22:23], v124, s[8:11], s25 offen
    s_mov_b64 exec, -1
    v_cmp_le_i32 s[42:43], 0, v19
    s_mov_b64 exec, s[42:43]
    v_lshlrev_b32 v124, 15, v19
    v_lshrrev_b32 v124, 12, v124
    buffer_load_dwordx2 v[24:25], v124, s[8:11], s25 offen
    s_mov_b64 exec, -1
    s_waitcnt vmcnt(0)
    v_lshlrev_b32 v122, 16, v20
    v_mul_f32 v122, v2, v122
    s_mov_b64 exec, s[40:41]
    v_lshlrev_b32 v110, 16, v23
    v_and_b32 v112, v3, v23
    v_mul_f32 v110, v122, v110
    v_mul_f32 v112, v122, v112
    v_lshrrev_b32 v22, 14, v18
    v_cvt_i32_f32 v110, v110
    v_cvt_i32_f32 v112, v112
    v_and_b32 v22, 0xfff8, v22
    v_ashrrev_i32 v111, 31, v110
    v_ashrrev_i32 v113, 31, v112
    ds_add_u64 v22, v[110:111]
    ds_add_u64 v22, v[112:113] offset:50176
    s_mov_b64 exec, -1
    v_and_b32 v122, v3, v20
    v_mul_f32 v122, v2, v122
    s_mov_b64 exec, s[42:43]
    v_lshlrev_b32 v110, 16, v25
    v_and_b32 v112, v3, v25
    v_mul_f32 v110, v122, v110
    v_mul_f32 v112, v122, v112
    v_lshrrev_b32 v24, 14, v19
    v_cvt_i32_f32 v110, v110
    v_cvt_i32_f32 v112, v112
    v_and_b32 v24, 0xfff8, v24
    v_ashrrev_i32 v111, 31, v110
    v_ashrrev_i32 v113, 31, v112
    ds_add_u64 v24, v[110:111]
    ds_add_u64 v24, v[112:113] offset:50176
    s_mov_b64 exec, -1
    s_add_u32 s29, s29, 128
    s_branch P_rb1_piece
P_rb1_next:
    s_add_u32 s28, s28, 1
    s_cmp_lt_u32 s28, 80
    s_cbranch_scc1 P_rb_run1
    v_mov_b32 v6, v7
    v_mov_b32 v10, v11
    v_mov_b32 v7, v8
    v_mov_b32 v11, v12
    v_mov_b32 v8, v9
    v_mov_b32 v12, v13
    s_add_u32 s25, s25, 1600000
    s_sub_u32 s66, s66, 1
    s_cmp_lg_u32 s66, 0
    s_cbranch_scc1 P_rb_q1
    s_waitcnt lgkmcnt(0)
    s_barrier
    s_mov_b32 s76, 0
    s_mov_b32 s77, 0x41f00000
    s_mov_b32 s28, 0
P_rb_out1:
    v_add_u32 v18, s28, v0
    v_cmp_gt_u32 vcc, 6272, v18
    s_and_saveexec_b64 s[34:35], vcc
    v_lshlrev_b32 v30, 3, v18
    ds_read_b64 v[20:21], v30
    ds_read_b64 v[22:23], v30 offset:50176
    v_lshlrev_b32 v18, 3, v18
    s_waitcnt lgkmcnt(0)
    v_cvt_f64_i32 v[30:31], v21
    v_cvt_f64_u32 v[32:33], v20
    v_fma_f64 v[30:31], v[30:31], s[76:77], v[32:33]
    v_cvt_f32_f64 v24, v[30:31]
    v_mul_f32 v24, s72, v24
    v_cvt_f64_i32 v[30:31], v23
    v_cvt_f64_u32 v[32:33], v22
    v_fma_f64 v[30:31], v[30:31], s[76:77], v[32:33]
    v_cvt_f32_f64 v25, v[30:31]
    v_mul_f32 v25, s72, v25
    v_cvt_pk_bf16_f32 v24, v24, v25
    buffer_store_dword v24, v18, s[4:7], s74 offen offset:4
    s_mov_b64 exec, s[34:35]
    s_add_u32 s28, s28, 1024
    s_cmp_lt_u32 s28, 6272
    s_cbranch_scc1 P_rb_out1
P_end_rt:
P_end:
    s_endpgm
.globl fin_kernel
.p2align 8
.type fin_kernel,@function
fin_kernel:
    s_cmp_ge_u32 s2, 3125
    s_cbranch_scc1 F_end
    s_load_dwordx2 s[76:77], s[0:1], 0
    s_load_dwordx2 s[78:79], s[0:1], 24
    s_load_dwordx2 s[80:81], s[0:1], 88
    s_load_dwordx2 s[82:83], s[0:1], 104
    s_load_dwordx4 s[84:87], s[0:1], 56
    s_load_dwordx4 s[88:91], s[0:1], 72
    s_load_dwordx2 s[92:93], s[0:1], 40
    s_mul_i32 s3, s2, 256
    v_add_u32 v1, s3, v0
    v_lshrrev_b32 v2, 6, v1
    v_and_b32 v2, 127, v2
    v_lshrrev_b32 v3, 7, v1
    v_bfi_b32 v3, 63, v1, v3
    v_mul_u32_u24 v2, 12544, v2
    v_add_u32 v2, v2, v3
    v_lshlrev_b32 v4, 3, v2
    v_lshlrev_b32 v14, 1, v1
    v_lshlrev_b32 v15, 3, v1
    s_waitcnt lgkmcnt(0)
    s_load_dwordx16 s[24:39], s[84:85], 0
    s_load_dwordx16 s[40:55], s[86:87], 0
    s_load_dwordx8 s[56:63], s[88:89], 0
    s_load_dwordx8 s[64:71], s[90:91], 0
    s_load_dwordx4 s[72:75], s[92:93], 0
    s_mov_b32 s8, s76
    s_and_b32 s9, s77, 0xffff
    s_mov_b32 s10, 6400000
    s_mov_b32 s11, 0x00020000
    s_mov_b32 s12, s78
    s_and_b32 s13, s79, 0xffff
    s_mov_b32 s14, 1600000
    s_mov_b32 s15, 0x00020000
    s_mov_b32 s16, s80
    s_and_b32 s17, s81, 0xffff
    s_mov_b32 s18, 6400000
    s_mov_b32 s19, 0x00020000
    s_add_u32 s82, s82, 200000000
    s_addc_u32 s83, s83, 0
    s_mov_b32 s4, s82
    s_and_b32 s5, s83, 0xffff
    s_mov_b32 s6, 12845056
    s_mov_b32 s7, 0x00020000
    s_mov_b32 s23, 50176
    buffer_load_ushort v14, v14, s[12:15], 0 offen
    buffer_load_dwordx2 v[8:9], v4, s[4:7], s23 offen
    buffer_load_dwordx2 v[10:11], v4, s[4:7], 0 offen
    buffer_load_dwordx2 v[12:13], v15, s[8:11], 0 offen
    s_mov_b32 s20, 0xffff0000
    v_mov_b32 v1, 0xc166d4ca
    s_waitcnt lgkmcnt(0)
    s_waitcnt vmcnt(3)
    v_lshlrev_b32 v14, 16, v14
    s_lshl_b32 s21, s72, 16
    v_subrev_f32 v16, s21, v14
    s_and_b32 s21, s72, s20
    v_subrev_f32 v17, s21, v14
    s_lshl_b32 s21, s73, 16
    v_subrev_f32 v18, s21, v14
    s_and_b32 s21, s73, s20
    v_subrev_f32 v19, s21, v14
    s_lshl_b32 s21, s74, 16
    v_subrev_f32 v20, s21, v14
    s_and_b32 s21, s74, s20
    v_subrev_f32 v21, s21, v14
    s_lshl_b32 s21, s75, 16
    v_subrev_f32 v22, s21, v14
    s_and_b32 s21, s75, s20
    v_subrev_f32 v23, s21, v14
    v_mul_f32 v16, v16, v16
    v_mul_f32 v17, v17, v17
    v_mul_f32 v18, v18, v18
    v_mul_f32 v19, v19, v19
    v_mul_f32 v20, v20, v20
    v_mul_f32 v21, v21, v21
    v_mul_f32 v22, v22, v22
    v_mul_f32 v23, v23, v23
    v_mul_f32 v16, v1, v16
    v_mul_f32 v17, v1, v17
    v_mul_f32 v18, v1, v18
    v_mul_f32 v19, v1, v19
    v_mul_f32 v20, v1, v20
    v_mul_f32 v21, v1, v21
    v_mul_f32 v22, v1, v22
    v_mul_f32 v23, v1, v23
    v_exp_f32 v16, v16
    v_exp_f32 v17, v17
    v_exp_f32 v18, v18
    v_exp_f32 v19, v19
    v_exp_f32 v20, v20
    v_exp_f32 v21, v21
    v_exp_f32 v22, v22
    v_exp_f32 v23, v23
    s_nop 0
    s_lshl_b32 s21, s40, 16
    v_mul_f32 v24, s21, v16
    s_lshl_b32 s21, s24, 16
    v_mul_f32 v28, s21, v16
    s_lshl_b32 s21, s42, 16
    v_fmac_f32 v24, s21, v17
    s_lshl_b32 s21, s26, 16
    v_fmac_f32 v28, s21, v17
    s_lshl_b32 s21, s44, 16
    v_fmac_f32 v24, s21, v18
    s_lshl_b32 s21, s28, 16
    v_fmac_f32 v28, s21, v18
    s_lshl_b32 s21, s46, 16
    v_fmac_f32 v24, s21, v19
    s_lshl_b32 s21, s30, 16
    v_fmac_f32 v28, s21, v19
    s_lshl_b32 s21, s48, 16
    v_fmac_f32 v24, s21, v20
    s_lshl_b32 s21, s32, 16
    v_fmac_f32 v28, s21, v20
    s_lshl_b32 s21, s50, 16
    v_fmac_f32 v24, s21, v21
    s_lshl_b32 s21, s34, 16
    v_fmac_f32 v28, s21, v21
    s_lshl_b32 s21, s52, 16
    v_fmac_f32 v24, s21, v22
    s_lshl_b32 s21, s36, 16
    v_fmac_f32 v28, s21, v22
    s_lshl_b32 s21, s54, 16
    v_fmac_f32 v24, s21, v23
    s_lshl_b32 s21, s38, 16
    v_fmac_f32 v28, s21, v23
    s_and_b32 s21, s40, s20
    v_mul_f32 v25, s21, v16
    s_and_b32 s21, s24, s20
    v_mul_f32 v29, s21, v16
    s_and_b32 s21, s42, s20
    v_fmac_f32 v25, s21, v17
    s_and_b32 s21, s26, s20
    v_fmac_f32 v29, s21, v17
    s_and_b32 s21, s44, s20
    v_fmac_f32 v25, s21, v18
    s_and_b32 s21, s28, s20
    v_fmac_f32 v29, s21, v18
    s_and_b32 s21, s46, s20
    v_fmac_f32 v25, s21, v19
    s_and_b32 s21, s30, s20
    v_fmac_f32 v29, s21, v19
    s_and_b32 s21, s48, s20
    v_fmac_f32 v25, s21, v20
    s_and_b32 s21, s32, s20
    v_fmac_f32 v29, s21, v20
    s_and_b32 s21, s50, s20
    v_fmac_f32 v25, s21, v21
    s_and_b32 s21, s34, s20
    v_fmac_f32 v29, s21, v21
    s_and_b32 s21, s52, s20
    v_fmac_f32 v25, s21, v22
    s_and_b32 s21, s36, s20
    v_fmac_f32 v29, s21, v22
    s_and_b32 s21, s54, s20
    v_fmac_f32 v25, s21, v23
    s_and_b32 s21, s38, s20
    v_fmac_f32 v29, s21, v23
    s_lshl_b32 s21, s41, 16
    v_mul_f32 v26, s21, v16
    s_lshl_b32 s21, s25, 16
    v_mul_f32 v30, s21, v16
    s_lshl_b32 s21, s43, 16
    v_fmac_f32 v26, s21, v17
    s_lshl_b32 s21, s27, 16
    v_fmac_f32 v30, s21, v17
    s_lshl_b32 s21, s45, 16
    v_fmac_f32 v26, s21, v18
    s_lshl_b32 s21, s29, 16
    v_fmac_f32 v30, s21, v18
    s_lshl_b32 s21, s47, 16
    v_fmac_f32 v26, s21, v19
    s_lshl_b32 s21, s31, 16
    v_fmac_f32 v30, s21, v19
    s_lshl_b32 s21, s49, 16
    v_fmac_f32 v26, s21, v20
    s_lshl_b32 s21, s33, 16
    v_fmac_f32 v30, s21, v20
    s_lshl_b32 s21, s51, 16
    v_fmac_f32 v26, s21, v21
    s_lshl_b32 s21, s35, 16
    v_fmac_f32 v30, s21, v21
    s_lshl_b32 s21, s53, 16
    v_fmac_f32 v26, s21, v22
    s_lshl_b32 s21, s37, 16
    v_fmac_f32 v30, s21, v22
    s_lshl_b32 s21, s55, 16
    v_fmac_f32 v26, s21, v23
    s_lshl_b32 s21, s39, 16
    v_fmac_f32 v30, s21, v23
    s_and_b32 s21, s41, s20
    v_mul_f32 v27, s21, v16
    s_and_b32 s21, s25, s20
    v_mul_f32 v31, s21, v16
    s_and_b32 s21, s43, s20
    v_fmac_f32 v27, s21, v17
    s_and_b32 s21, s27, s20
    v_fmac_f32 v31, s21, v17
    s_and_b32 s21, s45, s20
    v_fmac_f32 v27, s21, v18
    s_and_b32 s21, s29, s20
    v_fmac_f32 v31, s21, v18
    s_and_b32 s21, s47, s20
    v_fmac_f32 v27, s21, v19
    s_and_b32 s21, s31, s20
    v_fmac_f32 v31, s21, v19
    s_and_b32 s21, s49, s20
    v_fmac_f32 v27, s21, v20
    s_and_b32 s21, s33, s20
    v_fmac_f32 v31, s21, v20
    s_and_b32 s21, s51, s20
    v_fmac_f32 v27, s21, v21
    s_and_b32 s21, s35, s20
    v_fmac_f32 v31, s21, v21
    s_and_b32 s21, s53, s20
    v_fmac_f32 v27, s21, v22
    s_and_b32 s21, s37, s20
    v_fmac_f32 v31, s21, v22
    s_and_b32 s21, s55, s20
    v_fmac_f32 v27, s21, v23
    s_and_b32 s21, s39, s20
    v_fmac_f32 v31, s21, v23
    s_waitcnt vmcnt(0)
    v_lshlrev_b32 v4, 16, v8
    v_and_b32 v5, s20, v8
    v_lshlrev_b32 v6, 16, v9
    v_and_b32 v7, s20, v9
    v_lshlrev_b32 v16, 16, v10
    v_and_b32 v17, s20, v10
    v_add_f32 v4, v4, v16
    v_add_f32 v5, v5, v17
    v_lshlrev_b32 v16, 16, v11
    v_and_b32 v17, s20, v11
    v_add_f32 v6, v6, v16
    v_add_f32 v7, v7, v17
    s_lshl_b32 s21, s56, 16
    v_mul_f32 v8, s21, v4
    s_lshl_b32 s21, s58, 16
    v_fmac_f32 v8, s21, v5
    s_lshl_b32 s21, s60, 16
    v_fmac_f32 v8, s21, v6
    s_lshl_b32 s21, s62, 16
    v_fmac_f32 v8, s21, v7
    v_mul_f32 v8, v24, v8
    s_and_b32 s21, s56, s20
    v_mul_f32 v9, s21, v4
    s_and_b32 s21, s58, s20
    v_fmac_f32 v9, s21, v5
    s_and_b32 s21, s60, s20
    v_fmac_f32 v9, s21, v6
    s_and_b32 s21, s62, s20
    v_fmac_f32 v9, s21, v7
    v_mul_f32 v9, v25, v9
    s_lshl_b32 s21, s57, 16
    v_mul_f32 v10, s21, v4
    s_lshl_b32 s21, s59, 16
    v_fmac_f32 v10, s21, v5
    s_lshl_b32 s21, s61, 16
    v_fmac_f32 v10, s21, v6
    s_lshl_b32 s21, s63, 16
    v_fmac_f32 v10, s21, v7
    v_mul_f32 v10, v26, v10
    s_and_b32 s21, s57, s20
    v_mul_f32 v11, s21, v4
    s_and_b32 s21, s59, s20
    v_fmac_f32 v11, s21, v5
    s_and_b32 s21, s61, s20
    v_fmac_f32 v11, s21, v6
    s_and_b32 s21, s63, s20
    v_fmac_f32 v11, s21, v7
    v_mul_f32 v11, v27, v11
    s_lshl_b32 s21, s64, 16
    v_mul_f32 v24, s21, v8
    s_lshl_b32 s21, s66, 16
    v_fmac_f32 v24, s21, v9
    s_lshl_b32 s21, s68, 16
    v_fmac_f32 v24, s21, v10
    s_lshl_b32 s21, s70, 16
    v_fmac_f32 v24, s21, v11
    s_and_b32 s21, s64, s20
    v_mul_f32 v25, s21, v8
    s_and_b32 s21, s66, s20
    v_fmac_f32 v25, s21, v9
    s_and_b32 s21, s68, s20
    v_fmac_f32 v25, s21, v10
    s_and_b32 s21, s70, s20
    v_fmac_f32 v25, s21, v11
    s_lshl_b32 s21, s65, 16
    v_mul_f32 v26, s21, v8
    s_lshl_b32 s21, s67, 16
    v_fmac_f32 v26, s21, v9
    s_lshl_b32 s21, s69, 16
    v_fmac_f32 v26, s21, v10
    s_lshl_b32 s21, s71, 16
    v_fmac_f32 v26, s21, v11
    s_and_b32 s21, s65, s20
    v_mul_f32 v27, s21, v8
    s_and_b32 s21, s67, s20
    v_fmac_f32 v27, s21, v9
    s_and_b32 s21, s69, s20
    v_fmac_f32 v27, s21, v10
    s_and_b32 s21, s71, s20
    v_fmac_f32 v27, s21, v11
    v_lshlrev_b32 v4, 16, v12
    v_and_b32 v5, s20, v12
    v_lshlrev_b32 v6, 16, v13
    v_and_b32 v7, s20, v13
    v_fmac_f32 v4, v24, v28
    v_fmac_f32 v5, v25, v29
    v_fmac_f32 v6, v26, v30
    v_fmac_f32 v7, v27, v31
    v_cvt_pk_bf16_f32 v8, v4, v5
    v_cvt_pk_bf16_f32 v9, v6, v7
    buffer_store_dwordx2 v[8:9], v15, s[16:19], 0 offen
F_end:
    s_endpgm
.section .rodata,"a"
.p2align 6
.amdhsa_kernel part_kernel
  .amdhsa_next_free_vgpr 128
  .amdhsa_next_free_sgpr 64
  .amdhsa_accum_offset 128
  .amdhsa_group_segment_fixed_size 0
  .amdhsa_kernarg_size 112
  .amdhsa_user_sgpr_count 2
  .amdhsa_user_sgpr_kernarg_segment_ptr 1
  .amdhsa_system_sgpr_workgroup_id_x 1
  .amdhsa_float_denorm_mode_32 3
.end_amdhsa_kernel
.p2align 6
.amdhsa_kernel acc_kernel
  .amdhsa_next_free_vgpr 128
  .amdhsa_next_free_sgpr 102
  .amdhsa_accum_offset 128
  .amdhsa_group_segment_fixed_size 0
  .amdhsa_kernarg_size 112
  .amdhsa_user_sgpr_count 2
  .amdhsa_user_sgpr_kernarg_segment_ptr 1
  .amdhsa_system_sgpr_workgroup_id_x 1
  .amdhsa_float_denorm_mode_32 3
.end_amdhsa_kernel
.p2align 6
.amdhsa_kernel fin_kernel
  .amdhsa_next_free_vgpr 34
  .amdhsa_next_free_sgpr 96
  .amdhsa_accum_offset 36
  .amdhsa_group_segment_fixed_size 0
  .amdhsa_kernarg_size 112
  .amdhsa_user_sgpr_count 2
  .amdhsa_user_sgpr_kernarg_segment_ptr 1
  .amdhsa_system_sgpr_workgroup_id_x 1
  .amdhsa_float_denorm_mode_32 3
.end_amdhsa_kernel
```
